```python
import torch

def _softmax(x, axis=-1):
    return torch.softmax(x, dim=axis)
def _gelu(x):
    return torch.nn.functional.gelu(x, approximate="tanh")
def _silu(x):
    return torch.nn.functional.silu(x)
def _sigmoid(x):
    return torch.sigmoid(x)
def _layernorm(x, axis=-1, eps=1e-5):
    m = x.mean(dim=axis, keepdim=True)
    v = x.var(dim=axis, keepdim=True, unbiased=False)
    return (x - m) / torch.sqrt(v + eps)
def _scatter_add(tgt, idx, src, axis=0):
    return tgt.clone().index_add_(axis, idx, src)
def _segment_sum(src, seg, n):
    out = torch.zeros((n,) + src.shape[1:], dtype=src.dtype)
    return out.index_add_(0, seg, src)
def _pad(x, pw):
    flat = tuple(v for pair in reversed(pw) for v in pair)
    return torch.nn.functional.pad(x, flat)

kernel_name = 'concat_heads__compressed_kv_cla__gqa_block_cached__decode'

def setup_inputs():

    _w = (lambda a: (lambda t: t.to(torch.bfloat16) if t.is_floating_point() else t)(torch.as_tensor(a)))
    def _A_setup():
        B, H, Sq, Sk, D, M = 1, 32, 1, 16384, 128, 512
        Dc = 4 * D
        return {
            "x": _w((lambda *s: torch.randn(*s, dtype=torch.bfloat16) * 3.2)(B, Sq, M)),
            "c_kv": _w((lambda *s: torch.randn(*s, dtype=torch.bfloat16) * 0.1)(B, Sk, Dc)),
            "w_q": _w((lambda *s: torch.randn(*s, dtype=torch.bfloat16) * 6.4)(M, H, D) * (M ** -0.5)),
            "w_uk": _w((lambda *s: torch.randn(*s, dtype=torch.bfloat16) * 6.4)(Dc, H, D) * (Dc ** -0.5)),
            "w_uv": _w((lambda *s: torch.randn(*s, dtype=torch.bfloat16) * 0.1)(Dc, H, D) * (Dc ** -0.5)),
            "w_o": _w((lambda *s: torch.randn(*s, dtype=torch.bfloat16) * 0.1)(H, D, M) * ((H * D) ** -0.5)),
        }
    _A_in = _A_setup()

    def _B_setup():
        B, Sq, D = 1, 1, 512
        Hq, Hkv, Sk, Dh = 32, 8, 16384, 128
        assert Hq % Hkv == 0, (Hq, Hkv)
        return {
            "x": _w((lambda *s: torch.randn(*s, dtype=torch.bfloat16) * 1.6)(B, Sq, D)),
            "k_cache": _w((lambda *s: torch.randn(*s, dtype=torch.bfloat16) * 1.6)(B, Hkv, Sk, Dh)),
            "v_cache": _w((lambda *s: torch.randn(*s, dtype=torch.bfloat16) * 0.05)(B, Hkv, Sk, Dh)),
            "wq": _w((lambda *s: torch.randn(*s, dtype=torch.bfloat16) * 1.6)(D, Hq * Dh) * (D ** -0.5)),
            "wo": _w((lambda *s: torch.randn(*s, dtype=torch.bfloat16) * 0.05)(Hq * Dh, D) * ((Hq * Dh) ** -0.5)),
        }
    _B_in = _B_setup()

    return {
        "A_x": _A_in["x"],
        "A_c_kv": _A_in["c_kv"],
        "A_w_q": _A_in["w_q"],
        "A_w_uk": _A_in["w_uk"],
        "A_w_uv": _A_in["w_uv"],
        "A_w_o": _A_in["w_o"],
        "B_x": _B_in["x"],
        "B_k_cache": _B_in["k_cache"],
        "B_v_cache": _B_in["v_cache"],
        "B_wq": _B_in["wq"],
        "B_wo": _B_in["wo"],
    }

def reference(A_x, A_c_kv, A_w_q, A_w_uk, A_w_uv, A_w_o, B_x, B_k_cache, B_v_cache, B_wq, B_wo):
    def _A_ref(x, c_kv, w_q, w_uk, w_uv, w_o):
        B, Sq, M = x.shape[0], x.shape[1], x.shape[2]
        Sk = c_kv.shape[1]
        H, D = w_q.shape[1], w_q.shape[2]
        q = torch.einsum("bqm,mhd->bhqd", x, w_q)
        k = torch.einsum("bkc,chd->bhkd", c_kv, w_uk)
        v = torch.einsum("bkc,chd->bhkd", c_kv, w_uv)
        scores = torch.einsum("bhqd,bhkd->bhqk", q, k) * (D ** -0.5)
        off = Sk - Sq
        qi = torch.arange(Sq)[:, None]
        kj = torch.arange(Sk)[None, :]
        cmask = kj <= (qi + off)
        scores = torch.where(cmask[None, None], scores, -1e9)
        p = _softmax(scores, axis=-1)
        ctx = torch.einsum("bhqk,bhkd->bhqd", p, v)
        return torch.einsum("bhqd,hdm->bqm", ctx, w_o)

    def _B_ref(x, k_cache, v_cache, wq, wo):
        B, Sq, D = x.shape
        Hq, Dh = 32, 128
        Hkv = k_cache.shape[1]
        rep = Hq // Hkv
        q = (lambda x, *d: x.permute(*d))((x @ wq).reshape(B, Sq, Hq, Dh), 0, 2, 1, 3)
        k = (lambda x, n, axis: torch.repeat_interleave(x, n, dim=axis))(k_cache, rep, axis=1)
        v = (lambda x, n, axis: torch.repeat_interleave(x, n, dim=axis))(v_cache, rep, axis=1)
        scores = torch.einsum("bhqd,bhkd->bhqk", q, k) * (Dh ** -0.5)
        p = _softmax(scores, axis=-1)
        o = torch.einsum("bhqk,bhkd->bhqd", p, v)
        return (lambda x, *d: x.permute(*d))(o, 0, 2, 1, 3).reshape(B, Sq, Hq * Dh) @ wo

    a = _A_ref(A_x, A_c_kv, A_w_q, A_w_uk, A_w_uv, A_w_o)
    b = _B_ref(B_x, B_k_cache, B_v_cache, B_wq, B_wo)
    return torch.concatenate([a, b], axis=-1)
```

```asm
; @launch grid=(256,1,1) block=(512,1,1) lds=163840
.amdgcn_target "amdgcn-amd-amdhsa--gfx950"
.text
.globl concat_heads__compressed_kv_cla__gqa_block_cached__decode_kernel
.p2align 8
.type concat_heads__compressed_kv_cla__gqa_block_cached__decode_kernel,@function
concat_heads__compressed_kv_cla__gqa_block_cached__decode_kernel:
    s_cmp_ge_u32 s2, 256
    s_cbranch_scc1 L_end
    s_load_dwordx16 s[16:31], s[0:1], 0
    s_load_dwordx8 s[32:39], s[0:1], 64
    s_load_dwordx4 s[40:43], s[0:1], 96
    v_lshrrev_b32 v6, 6, v0
    v_and_b32 v1, 63, v0
    v_and_b32 v2, 15, v0
    v_bfe_u32 v3, v0, 4, 2
    v_readfirstlane_b32 s6, v6
    s_and_b32 s7, s2, 7
    s_lshr_b32 s8, s2, 3
    v_and_b32 v7, 3, v0
    v_lshlrev_b32 v7, 4, v7
    v_lshl_add_u32 v7, v3, 6, v7
    v_and_b32 v8, 7, v0
    v_lshlrev_b32 v10, 4, v1
    s_cmp_lt_u32 s8, 8
    s_cbranch_scc1 L_astream
    s_sub_u32 s64, s8, 8
    s_mul_i32 s9, s64, 43
    s_lshr_b32 s9, s9, 8
    s_mul_i32 s3, s9, 6
    s_sub_u32 s10, s64, s3
    s_add_u32 s9, s9, 2
    s_and_b32 s9, s9, 3
    s_lshl_b32 s3, s7, 2
    s_add_u32 s9, s9, s3
    s_mul_i32 s3, s10, 786432
    s_lshl_b32 s12, s9, 8
    s_add_u32 s61, s3, s12
    v_lshrrev_b32 v6, 4, v0
    v_lshlrev_b32 v4, 13, v6
    v_lshl_add_u32 v4, v2, 4, v4
    v_add_u32 v4, s61, v4
    v_add_u32 v11, 0x40000, v4
    v_add_u32 v12, 0x80000, v4
    s_mul_i32 s12, s10, 192
    v_lshl_add_u32 v6, v6, 1, s12
    s_mov_b32 s50, 0x400000
    s_mov_b32 s51, 0x20000
    s_movk_i32 s58, 0x400
    s_mov_b32 s59, 0x20000
    s_movk_i32 s46, 0x400
    s_mov_b32 s47, 0x20000
    s_cmp_eq_u32 s6, 7
    s_waitcnt lgkmcnt(0)
    s_cbranch_scc0 L_nowarm
    s_lshl_b32 s14, s9, 14
    s_add_u32 s14, s14, 65536
    s_add_u32 s4, s42, s14
    s_addc_u32 s5, s43, 0
    v_lshlrev_b32 v9, 3, v10
    v_add_u32 v13, 0x2000, v9
    global_load_dword v5, v9, s[4:5] nt
    s_mov_b32 exec_hi, 0
    global_load_dword v5, v13, s[4:5] nt
    s_lshl_b32 s14, s7, 11
    s_add_u32 s14, s14, 688128
    s_add_u32 s4, s42, s14
    s_addc_u32 s5, s43, 0
    s_mov_b32 exec_lo, 0xffff
    global_load_dword v5, v9, s[4:5] nt
    s_mov_b64 exec, -1
    s_cmp_eq_u32 s6, 7
L_nowarm:
    s_mov_b32 s48, s20
    s_mov_b32 s49, s21
    s_mov_b32 s56, s16
    s_mov_b32 s57, s17
    buffer_load_ushort v16, v6, s[56:59], 0 offen offset:0
    buffer_load_ushort v17, v6, s[56:59], 0 offen offset:64
    buffer_load_ushort v18, v6, s[56:59], 0 offen offset:128
    buffer_load_dwordx4 v[128:131], v4, s[48:51], 0 offen nt
    buffer_load_dwordx4 v[132:135], v11, s[48:51], 0 offen nt
    buffer_load_dwordx4 v[136:139], v12, s[48:51], 0 offen nt
    s_mov_b32 s44, s28
    s_mov_b32 s45, s29
    buffer_load_ushort v19, v6, s[44:47], 0 offen offset:0
    buffer_load_ushort v20, v6, s[44:47], 0 offen offset:64
    buffer_load_ushort v21, v6, s[44:47], 0 offen offset:128
    v_mov_b32 v22, v4
    s_cbranch_scc0 L_notctrl
    s_load_dword s11, s[42:43], 0
    v_bfe_u32 v14, v0, 2, 2
    v_lshl_add_u32 v9, v14, 15, v7
    v_add_u32 v9, s61, v9
    v_lshl_add_u32 v14, v14, 14, v7
    v_add_u32 v14, s61, v14
    s_mov_b32 s56, s22
    s_mov_b32 s57, s23
    s_mov_b32 s58, 4194304
    s_mov_b32 s59, 0x20000
    v_add_u32 v23, 0x80000, v14
    buffer_load_dwordx4 v[160:163], v9, s[56:59], 0 offen nt
    v_add_u32 v9, 0x2000, v9
    buffer_load_dwordx4 v[176:179], v9, s[56:59], 0 offen nt
    v_add_u32 v9, 0x2000, v9
    buffer_load_dwordx4 v[192:195], v9, s[56:59], 0 offen nt
    v_add_u32 v9, 0x2000, v9
    buffer_load_dwordx4 v[208:211], v9, s[56:59], 0 offen nt
    v_add_u32 v9, 0x1a000, v9
    buffer_load_dwordx4 v[164:167], v9, s[56:59], 0 offen nt
    v_add_u32 v9, 0x2000, v9
    buffer_load_dwordx4 v[180:183], v9, s[56:59], 0 offen nt
    v_add_u32 v9, 0x2000, v9
    buffer_load_dwordx4 v[196:199], v9, s[56:59], 0 offen nt
    v_add_u32 v9, 0x2000, v9
    buffer_load_dwordx4 v[212:215], v9, s[56:59], 0 offen nt
    v_add_u32 v9, 0x1a000, v9
    buffer_load_dwordx4 v[168:171], v9, s[56:59], 0 offen nt
    v_add_u32 v9, 0x2000, v9
    buffer_load_dwordx4 v[184:187], v9, s[56:59], 0 offen nt
    v_add_u32 v9, 0x2000, v9
    buffer_load_dwordx4 v[200:203], v9, s[56:59], 0 offen nt
    v_add_u32 v9, 0x2000, v9
    buffer_load_dwordx4 v[216:219], v9, s[56:59], 0 offen nt
    v_add_u32 v9, 0x1a000, v9
    buffer_load_dwordx4 v[172:175], v9, s[56:59], 0 offen nt
    v_add_u32 v9, 0x2000, v9
    buffer_load_dwordx4 v[188:191], v9, s[56:59], 0 offen nt
    v_add_u32 v9, 0x2000, v9
    buffer_load_dwordx4 v[204:207], v9, s[56:59], 0 offen nt
    v_add_u32 v9, 0x2000, v9
    buffer_load_dwordx4 v[220:223], v9, s[56:59], 0 offen nt
    buffer_load_dwordx4 v[224:227], v23, s[56:59], 0 offen nt
    v_add_u32 v23, 0x2000, v23
    buffer_load_dwordx4 v[240:243], v23, s[56:59], 0 offen nt
    v_add_u32 v23, 0xe000, v23
    buffer_load_dwordx4 v[228:231], v23, s[56:59], 0 offen nt
    v_add_u32 v23, 0x2000, v23
    buffer_load_dwordx4 v[244:247], v23, s[56:59], 0 offen nt
    v_add_u32 v23, 0xe000, v23
    buffer_load_dwordx4 v[232:235], v23, s[56:59], 0 offen nt
    v_add_u32 v23, 0x2000, v23
    buffer_load_dwordx4 v[248:251], v23, s[56:59], 0 offen nt
    v_add_u32 v23, 0xe000, v23
    buffer_load_dwordx4 v[236:239], v23, s[56:59], 0 offen nt
    v_add_u32 v23, 0x2000, v23
    buffer_load_dwordx4 v[252:255], v23, s[56:59], 0 offen nt
    s_mov_b32 s62, 0
    s_mov_b32 s63, -1
    s_mov_b32 s60, 0x3e0293ee
    s_mov_b32 s44, s42
    s_mov_b32 s45, s43
    s_mov_b32 s46, 8388608
    s_mov_b32 s47, 0x20000
    v_and_b32 v15, 3, v0
    v_lshlrev_b32 v15, 4, v15
    v_mov_b32 v13, 0
    v_mov_b32 v11, 0x0c0c0c0c
    v_and_b32 v14, 4, v0
    v_cmp_ne_u32 vcc, 0, v14
    v_mov_b32 v12, 0xd0c
    v_lshlrev_b64 v[32:33], v15, v[12:13]
    v_xor_b32 v32, v11, v32
    v_xor_b32 v33, v11, v33
    v_cndmask_b32 v36, v32, v11, vcc
    v_cndmask_b32 v37, v33, v11, vcc
    v_cndmask_b32 v38, v11, v32, vcc
    v_cndmask_b32 v39, v11, v33, vcc
    v_mov_b32 v12, 0xf0e
    v_lshlrev_b64 v[34:35], v15, v[12:13]
    v_xor_b32 v34, v11, v34
    v_xor_b32 v35, v11, v35
    v_cndmask_b32 v40, v34, v11, vcc
    v_cndmask_b32 v41, v35, v11, vcc
    v_cndmask_b32 v42, v11, v34, vcc
    v_cndmask_b32 v43, v11, v35, vcc
    s_waitcnt lgkmcnt(0)
    s_mul_i32 s11, s11, 0x9e3779b1
    s_add_u32 s11, s11, 0x7f4a7c15
    s_getreg_b32 s24, hwreg(HW_REG_XCC_ID, 0, 4)
    s_xor_b32 s25, s11, s24
    s_mov_b32 s28, 0
    v_mov_b32 v57, s11
    v_mov_b32 v59, s11
    ds_write_b32 v13, v57 offset:1544
    ds_write_b32 v13, v13 offset:1536
    ds_write_b32 v13, v13 offset:1540
    ds_write_b32 v13, v13 offset:1548
    ds_write_b32 v13, v13 offset:1552
    ds_write_b32 v13, v13 offset:1556
    s_waitcnt vmcnt(27)
    v_perm_b32 v44, v16, v16, v36
    v_perm_b32 v45, v16, v16, v37
    v_perm_b32 v46, v16, v16, v38
    v_perm_b32 v47, v16, v16, v39
    v_perm_b32 v48, v17, v17, v36
    v_perm_b32 v49, v17, v17, v37
    v_perm_b32 v50, v17, v17, v38
    v_perm_b32 v51, v17, v17, v39
    v_perm_b32 v52, v18, v18, v36
    v_perm_b32 v53, v18, v18, v37
    v_perm_b32 v54, v18, v18, v38
    v_perm_b32 v55, v18, v18, v39
    v_mfma_f32_16x16x32_bf16 v[152:155], v[44:47], v[128:131], 0
    v_mfma_f32_16x16x32_bf16 v[152:155], v[48:51], v[132:135], v[152:155]
    v_mfma_f32_16x16x32_bf16 v[152:155], v[52:55], v[136:139], v[152:155]
    v_lshlrev_b32 v11, 4, v0
    s_nop 6
    ds_write_b128 v11, v[152:155] offset:32768
    s_waitcnt lgkmcnt(0)
    s_barrier
    s_lshl_b32 s14, s9, 14
    s_add_u32 s14, s14, 65536
    s_lshl_b32 s15, s10, 11
    s_add_u32 s15, s15, s14
    v_and_b32 v11, 31, v1
    v_lshlrev_b32 v11, 4, v11
    v_lshrrev_b32 v12, 5, v1
    v_lshl_add_u32 v11, v12, 12, v11
    ds_read_b128 v[64:67], v11 offset:32768
    ds_read_b128 v[68:71], v11 offset:33792
    ds_read_b128 v[72:75], v11 offset:34816
    ds_read_b128 v[76:79], v11 offset:35840
    v_mov_b32 v113, s25
    v_mov_b32 v115, s25
    s_waitcnt lgkmcnt(2)
    v_pk_add_f32 v[64:65], v[64:65], v[68:69]
    v_pk_add_f32 v[66:67], v[66:67], v[70:71]
    s_waitcnt lgkmcnt(1)
    v_pk_add_f32 v[64:65], v[64:65], v[72:73]
    v_pk_add_f32 v[66:67], v[66:67], v[74:75]
    s_waitcnt lgkmcnt(0)
    v_pk_add_f32 v[64:65], v[64:65], v[76:77]
    v_pk_add_f32 v[66:67], v[66:67], v[78:79]
    s_nop 1
    v_permlane32_swap_b32 v64, v66
    v_permlane32_swap_b32 v65, v67
    v_add_f32 v112, v64, v66
    v_add_f32 v114, v65, v67
    buffer_store_dwordx4 v[112:115], v10, s[44:47], s15 offen
    s_mov_b32 s16, s34
    s_mov_b32 s17, s35
    s_mov_b32 s18, 4194304
    s_mov_b32 s19, 0x20000
    buffer_load_dwordx4 v[140:143], v22, s[16:19], 0 offen nt
    v_add_u32 v22, 0x40000, v22
    buffer_load_dwordx4 v[144:147], v22, s[16:19], 0 offen nt
    v_add_u32 v22, 0x40000, v22
    buffer_load_dwordx4 v[148:151], v22, s[16:19], 0 offen nt
    s_add_u32 s68, s15, 5242880
    v_mov_b32 v24, 0
    v_mov_b32 v25, 0
    v_mov_b32 v26, 0
    v_mov_b32 v27, 0
    v_mov_b32 v28, 0
    v_mov_b32 v29, 0
    v_mov_b32 v30, 0
    v_mov_b32 v31, 0
    v_mov_b32 v120, 0
    v_mov_b32 v121, 0
    v_mov_b32 v122, 0
    v_mov_b32 v123, 0
    v_mov_b32 v124, 0
    v_mov_b32 v125, 0
    v_mov_b32 v126, 0
    v_mov_b32 v127, 0
    v_and_b32 v9, 1, v3
    v_lshlrev_b32 v9, 3, v9
    v_lshl_add_u32 v9, v2, 4, v9
    v_lshrrev_b32 v12, 1, v3
    v_lshl_add_u32 v9, v12, 2, v9
    v_add_u32 v13, 40960, v9
    v_add_u32 v14, 40960, v7
    s_waitcnt vmcnt(3)
    s_add_u32 s12, s14, 0
    buffer_load_dwordx4 v[64:67], v10, s[44:47], s12 offen offset:0 sc1
    buffer_load_dwordx4 v[68:71], v10, s[44:47], s12 offen offset:2048 sc1
    s_add_u32 s12, s14, 4096
    buffer_load_dwordx4 v[72:75], v10, s[44:47], s12 offen offset:0 sc1
    buffer_load_dwordx4 v[76:79], v10, s[44:47], s12 offen offset:2048 sc1
    s_add_u32 s12, s14, 8192
    buffer_load_dwordx4 v[80:83], v10, s[44:47], s12 offen offset:0 sc1
    buffer_load_dwordx4 v[84:87], v10, s[44:47], s12 offen offset:2048 sc1
    s_waitcnt vmcnt(6)
    v_perm_b32 v44, v19, v19, v36
    v_perm_b32 v45, v19, v19, v37
    v_perm_b32 v46, v19, v19, v38
    v_perm_b32 v47, v19, v19, v39
    v_perm_b32 v48, v20, v20, v36
    v_perm_b32 v49, v20, v20, v37
    v_perm_b32 v50, v20, v20, v38
    v_perm_b32 v51, v20, v20, v39
    v_perm_b32 v52, v21, v21, v36
    v_perm_b32 v53, v21, v21, v37
    v_perm_b32 v54, v21, v21, v38
    v_perm_b32 v55, v21, v21, v39
    v_mfma_f32_16x16x32_bf16 v[152:155], v[44:47], v[140:143], 0
    v_mfma_f32_16x16x32_bf16 v[152:155], v[48:51], v[144:147], v[152:155]
    v_mfma_f32_16x16x32_bf16 v[152:155], v[52:55], v[148:151], v[152:155]
    v_lshlrev_b32 v11, 4, v0
    s_nop 6
    ds_write_b128 v11, v[152:155] offset:49152
    v_mov_b32 v15, 0
L_wqb_1:
    ds_read_b32 v60, v15 offset:1548
    s_waitcnt lgkmcnt(0)
    v_readfirstlane_b32 s3, v60
    s_nop 0
    s_cmp_lt_u32 s3, 7
    s_cbranch_scc1 L_wqb_1
    v_and_b32 v11, 31, v1
    v_lshlrev_b32 v11, 4, v11
    v_lshrrev_b32 v12, 5, v1
    v_lshl_add_u32 v11, v12, 12, v11
    ds_read_b128 v[96:99], v11 offset:49152
    ds_read_b128 v[100:103], v11 offset:50176
    ds_read_b128 v[104:107], v11 offset:51200
    ds_read_b128 v[108:111], v11 offset:52224
    v_mov_b32 v117, s25
    v_mov_b32 v119, s25
    s_waitcnt lgkmcnt(2)
    v_pk_add_f32 v[96:97], v[96:97], v[100:101]
    v_pk_add_f32 v[98:99], v[98:99], v[102:103]
    s_waitcnt lgkmcnt(1)
    v_pk_add_f32 v[96:97], v[96:97], v[104:105]
    v_pk_add_f32 v[98:99], v[98:99], v[106:107]
    s_waitcnt lgkmcnt(0)
    v_pk_add_f32 v[96:97], v[96:97], v[108:109]
    v_pk_add_f32 v[98:99], v[98:99], v[110:111]
    s_nop 1
    v_permlane32_swap_b32 v96, v98
    v_permlane32_swap_b32 v97, v99
    v_add_f32 v116, v96, v98
    v_add_f32 v118, v97, v99
    buffer_store_dwordx4 v[116:119], v10, s[44:47], s15 offen offset:1024
    s_waitcnt vmcnt(1)
    v_xor_b32 v60, s25, v65
    v_bitop3_b32 v60, v67, s25, v60 bitop3:0xbe
    v_bitop3_b32 v60, v69, s25, v60 bitop3:0xbe
    v_bitop3_b32 v60, v71, s25, v60 bitop3:0xbe
    v_bitop3_b32 v60, v73, s25, v60 bitop3:0xbe
    v_bitop3_b32 v60, v75, s25, v60 bitop3:0xbe
    v_bitop3_b32 v60, v77, s25, v60 bitop3:0xbe
    v_bitop3_b32 v60, v79, s25, v60 bitop3:0xbe
    v_bitop3_b32 v60, v81, s25, v60 bitop3:0xbe
    v_bitop3_b32 v60, v83, s25, v60 bitop3:0xbe
    v_bitop3_b32 v60, v85, s25, v60 bitop3:0xbe
    v_bitop3_b32 v60, v87, s25, v60 bitop3:0xbe
    v_cmp_ne_u32 vcc, 0, v60
    s_cbranch_vccnz L_p1_retry
L_p1_got:
    s_barrier
    v_add_f32 v64, v64, v68
    v_add_f32 v66, v66, v70
    v_add_f32 v64, v64, v72
    v_add_f32 v66, v66, v74
    v_add_f32 v64, v64, v76
    v_add_f32 v66, v66, v78
    v_add_f32 v64, v64, v80
    v_add_f32 v66, v66, v82
    v_add_f32 v64, v64, v84
    v_add_f32 v66, v66, v86
    v_cvt_pk_bf16_f32 v60, v64, v66
    ds_write_b32 v13, v60
    s_waitcnt lgkmcnt(0)
    s_mov_b32 exec_lo, 0xf000f
    s_mov_b32 exec_hi, 0xf000f
    ds_read_b128 v[24:27], v14
    s_mov_b32 exec_lo, 0xf000f0
    s_mov_b32 exec_hi, 0xf000f0
    ds_read_b128 v[28:31], v14
    s_mov_b32 exec_lo, 0xf000f00
    s_mov_b32 exec_hi, 0xf000f00
    ds_read_b128 v[120:123], v14
    s_mov_b32 exec_lo, 0xf000f000
    s_mov_b32 exec_hi, 0xf000f000
    ds_read_b128 v[124:127], v14
    s_mov_b64 exec, -1
    s_waitcnt lgkmcnt(0)
    v_mfma_f32_16x16x32_bf16 v[64:67], v[160:163], v[24:27], 0
    v_mfma_f32_16x16x32_bf16 v[64:67], v[164:167], v[28:31], v[64:67]
    v_mfma_f32_16x16x32_bf16 v[64:67], v[168:171], v[120:123], v[64:67]
    v_mfma_f32_16x16x32_bf16 v[64:67], v[172:175], v[124:127], v[64:67]
    v_mfma_f32_16x16x32_bf16 v[68:71], v[176:179], v[24:27], 0
    v_mfma_f32_16x16x32_bf16 v[68:71], v[180:183], v[28:31], v[68:71]
    v_mfma_f32_16x16x32_bf16 v[68:71], v[184:187], v[120:123], v[68:71]
    v_mfma_f32_16x16x32_bf16 v[68:71], v[188:191], v[124:127], v[68:71]
    v_mfma_f32_16x16x32_bf16 v[72:75], v[192:195], v[24:27], 0
    v_mfma_f32_16x16x32_bf16 v[72:75], v[196:199], v[28:31], v[72:75]
    v_mfma_f32_16x16x32_bf16 v[72:75], v[200:203], v[120:123], v[72:75]
    v_mfma_f32_16x16x32_bf16 v[72:75], v[204:207], v[124:127], v[72:75]
    v_mfma_f32_16x16x32_bf16 v[76:79], v[208:211], v[24:27], 0
    v_mfma_f32_16x16x32_bf16 v[76:79], v[212:215], v[28:31], v[76:79]
    v_mfma_f32_16x16x32_bf16 v[76:79], v[216:219], v[120:123], v[76:79]
    v_mfma_f32_16x16x32_bf16 v[76:79], v[220:223], v[124:127], v[76:79]
    v_mfma_f32_16x16x32_bf16 v[80:83], v[224:227], v[24:27], 0
    v_mfma_f32_16x16x32_bf16 v[80:83], v[228:231], v[28:31], v[80:83]
    v_mfma_f32_16x16x32_bf16 v[80:83], v[232:235], v[120:123], v[80:83]
    v_mfma_f32_16x16x32_bf16 v[80:83], v[236:239], v[124:127], v[80:83]
    v_mfma_f32_16x16x32_bf16 v[84:87], v[240:243], v[24:27], 0
    v_mfma_f32_16x16x32_bf16 v[84:87], v[244:247], v[28:31], v[84:87]
    v_mfma_f32_16x16x32_bf16 v[84:87], v[248:251], v[120:123], v[84:87]
    v_mfma_f32_16x16x32_bf16 v[84:87], v[252:255], v[124:127], v[84:87]
    s_lshl_b32 s12, s9, 11
    s_mul_i32 s3, s10, 384
    s_add_u32 s12, s12, s3
    s_add_u32 s12, s12, 589824
    v_and_b32 v15, 12, v2
    v_add_u32 v15, v15, v3
    v_lshlrev_b32 v14, 3, v15
    v_lshlrev_b32 v15, 4, v15
    s_mov_b32 s3, 0x00110011
    s_cmp_lt_u32 s10, 5
    s_cselect_b32 s3, 0x11111111, s3
    v_mov_b32_dpp v44, v64 quad_perm:[0,0,0,0] row_mask:0xf bank_mask:0xf
    v_mov_b32_dpp v45, v68 quad_perm:[0,0,0,0] row_mask:0xf bank_mask:0xf
    v_mov_b32_dpp v46, v72 quad_perm:[0,0,0,0] row_mask:0xf bank_mask:0xf
    v_mov_b32_dpp v47, v76 quad_perm:[0,0,0,0] row_mask:0xf bank_mask:0xf
    v_mov_b32_dpp v48, v80 quad_perm:[0,0,0,0] row_mask:0xf bank_mask:0xf
    v_mov_b32_dpp v49, v84 quad_perm:[0,0,0,0] row_mask:0xf bank_mask:0xf
    v_add_f32_dpp v44, v65, v44 quad_perm:[1,1,1,1] row_mask:0xf bank_mask:0xf
    v_add_f32_dpp v45, v69, v45 quad_perm:[1,1,1,1] row_mask:0xf bank_mask:0xf
    v_add_f32_dpp v46, v73, v46 quad_perm:[1,1,1,1] row_mask:0xf bank_mask:0xf
    v_add_f32_dpp v47, v77, v47 quad_perm:[1,1,1,1] row_mask:0xf bank_mask:0xf
    v_add_f32_dpp v48, v81, v48 quad_perm:[1,1,1,1] row_mask:0xf bank_mask:0xf
    v_add_f32_dpp v49, v85, v49 quad_perm:[1,1,1,1] row_mask:0xf bank_mask:0xf
    v_add_f32_dpp v44, v66, v44 quad_perm:[2,2,2,2] row_mask:0xf bank_mask:0xf
    v_add_f32_dpp v45, v70, v45 quad_perm:[2,2,2,2] row_mask:0xf bank_mask:0xf
    v_add_f32_dpp v46, v74, v46 quad_perm:[2,2,2,2] row_mask:0xf bank_mask:0xf
    v_add_f32_dpp v47, v78, v47 quad_perm:[2,2,2,2] row_mask:0xf bank_mask:0xf
    v_add_f32_dpp v48, v82, v48 quad_perm:[2,2,2,2] row_mask:0xf bank_mask:0xf
    v_add_f32_dpp v49, v86, v49 quad_perm:[2,2,2,2] row_mask:0xf bank_mask:0xf
    v_add_f32_dpp v44, v67, v44 quad_perm:[3,3,3,3] row_mask:0xf bank_mask:0xf
    v_add_f32_dpp v45, v71, v45 quad_perm:[3,3,3,3] row_mask:0xf bank_mask:0xf
    v_add_f32_dpp v46, v75, v46 quad_perm:[3,3,3,3] row_mask:0xf bank_mask:0xf
    v_add_f32_dpp v47, v79, v47 quad_perm:[3,3,3,3] row_mask:0xf bank_mask:0xf
    v_add_f32_dpp v48, v83, v48 quad_perm:[3,3,3,3] row_mask:0xf bank_mask:0xf
    v_add_f32_dpp v49, v87, v49 quad_perm:[3,3,3,3] row_mask:0xf bank_mask:0xf
    v_cvt_pk_bf16_f32 v56, v44, v45
    v_cvt_pk_bf16_f32 v58, v46, v47
    v_cvt_pk_bf16_f32 v62, v48, v49
    v_mov_b32 v63, s11
    s_mov_b32 exec_lo, s3
    s_mov_b32 exec_hi, s3
    buffer_store_dwordx4 v[56:59], v15, s[44:47], s12 offen sc1
    s_cbranch_scc0 L_p1done
    buffer_store_dwordx2 v[62:63], v14, s[44:47], s12 offen offset:256 sc1
L_p1done:
    s_mov_b64 exec, -1
    s_lshl_b32 s67, s7, 16
    s_add_u32 s67, s67, 65536
    s_mov_b32 s13, 0
    s_mov_b32 s26, s25
L_gqb_2:
    s_add_u32 s12, s67, 0
    buffer_load_dwordx4 v[160:163], v10, s[44:47], s12 offen offset:1024 sc1
    buffer_load_dwordx4 v[164:167], v10, s[44:47], s12 offen offset:3072 sc1
    s_add_u32 s12, s67, 4096
    buffer_load_dwordx4 v[168:171], v10, s[44:47], s12 offen offset:1024 sc1
    buffer_load_dwordx4 v[172:175], v10, s[44:47], s12 offen offset:3072 sc1
    s_add_u32 s12, s67, 8192
    buffer_load_dwordx4 v[176:179], v10, s[44:47], s12 offen offset:1024 sc1
    buffer_load_dwordx4 v[180:183], v10, s[44:47], s12 offen offset:3072 sc1
    s_add_u32 s12, s67, 16384
    buffer_load_dwordx4 v[184:187], v10, s[44:47], s12 offen offset:1024 sc1
    buffer_load_dwordx4 v[188:191], v10, s[44:47], s12 offen offset:3072 sc1
    s_add_u32 s12, s67, 20480
    buffer_load_dwordx4 v[192:195], v10, s[44:47], s12 offen offset:1024 sc1
    buffer_load_dwordx4 v[196:199], v10, s[44:47], s12 offen offset:3072 sc1
    s_add_u32 s12, s67, 24576
    buffer_load_dwordx4 v[200:203], v10, s[44:47], s12 offen offset:1024 sc1
    buffer_load_dwordx4 v[204:207], v10, s[44:47], s12 offen offset:3072 sc1
    s_add_u32 s12, s67, 32768
    buffer_load_dwordx4 v[208:211], v10, s[44:47], s12 offen offset:1024 sc1
    buffer_load_dwordx4 v[212:215], v10, s[44:47], s12 offen offset:3072 sc1
    s_add_u32 s12, s67, 36864
    buffer_load_dwordx4 v[216:219], v10, s[44:47], s12 offen offset:1024 sc1
    buffer_load_dwordx4 v[220:223], v10, s[44:47], s12 offen offset:3072 sc1
    s_add_u32 s12, s67, 40960
    buffer_load_dwordx4 v[224:227], v10, s[44:47], s12 offen offset:1024 sc1
    buffer_load_dwordx4 v[228:231], v10, s[44:47], s12 offen offset:3072 sc1
    s_add_u32 s12, s67, 49152
    buffer_load_dwordx4 v[232:235], v10, s[44:47], s12 offen offset:1024 sc1
    buffer_load_dwordx4 v[236:239], v10, s[44:47], s12 offen offset:3072 sc1
    s_add_u32 s12, s67, 53248
    buffer_load_dwordx4 v[240:243], v10, s[44:47], s12 offen offset:1024 sc1
    buffer_load_dwordx4 v[244:247], v10, s[44:47], s12 offen offset:3072 sc1
    s_add_u32 s12, s67, 57344
    buffer_load_dwordx4 v[248:251], v10, s[44:47], s12 offen offset:1024 sc1
    buffer_load_dwordx4 v[252:255], v10, s[44:47], s12 offen offset:3072 sc1
    s_add_u32 s13, s13, 1
    s_waitcnt vmcnt(0)
    v_xor_b32 v60, s26, v161
    v_bitop3_b32 v60, v163, s26, v60 bitop3:0xbe
    v_bitop3_b32 v60, v165, s26, v60 bitop3:0xbe
    v_bitop3_b32 v60, v167, s26, v60 bitop3:0xbe
    v_bitop3_b32 v60, v169, s26, v60 bitop3:0xbe
    v_bitop3_b32 v60, v171, s26, v60 bitop3:0xbe
    v_bitop3_b32 v60, v173, s26, v60 bitop3:0xbe
    v_bitop3_b32 v60, v175, s26, v60 bitop3:0xbe
    v_bitop3_b32 v60, v177, s26, v60 bitop3:0xbe
    v_bitop3_b32 v60, v179, s26, v60 bitop3:0xbe
    v_bitop3_b32 v60, v181, s26, v60 bitop3:0xbe
    v_bitop3_b32 v60, v183, s26, v60 bitop3:0xbe
    v_bitop3_b32 v60, v185, s26, v60 bitop3:0xbe
    v_bitop3_b32 v60, v187, s26, v60 bitop3:0xbe
    v_bitop3_b32 v60, v189, s26, v60 bitop3:0xbe
    v_bitop3_b32 v60, v191, s26, v60 bitop3:0xbe
    v_bitop3_b32 v60, v193, s26, v60 bitop3:0xbe
    v_bitop3_b32 v60, v195, s26, v60 bitop3:0xbe
    v_bitop3_b32 v60, v197, s26, v60 bitop3:0xbe
    v_bitop3_b32 v60, v199, s26, v60 bitop3:0xbe
    v_bitop3_b32 v60, v201, s26, v60 bitop3:0xbe
    v_bitop3_b32 v60, v203, s26, v60 bitop3:0xbe
    v_bitop3_b32 v60, v205, s26, v60 bitop3:0xbe
    v_bitop3_b32 v60, v207, s26, v60 bitop3:0xbe
    v_bitop3_b32 v60, v209, s26, v60 bitop3:0xbe
    v_bitop3_b32 v60, v211, s26, v60 bitop3:0xbe
    v_bitop3_b32 v60, v213, s26, v60 bitop3:0xbe
    v_bitop3_b32 v60, v215, s26, v60 bitop3:0xbe
    v_bitop3_b32 v60, v217, s26, v60 bitop3:0xbe
    v_bitop3_b32 v60, v219, s26, v60 bitop3:0xbe
    v_bitop3_b32 v60, v221, s26, v60 bitop3:0xbe
    v_bitop3_b32 v60, v223, s26, v60 bitop3:0xbe
    v_bitop3_b32 v60, v225, s26, v60 bitop3:0xbe
    v_bitop3_b32 v60, v227, s26, v60 bitop3:0xbe
    v_bitop3_b32 v60, v229, s26, v60 bitop3:0xbe
    v_bitop3_b32 v60, v231, s26, v60 bitop3:0xbe
    v_bitop3_b32 v60, v233, s26, v60 bitop3:0xbe
    v_bitop3_b32 v60, v235, s26, v60 bitop3:0xbe
    v_bitop3_b32 v60, v237, s26, v60 bitop3:0xbe
    v_bitop3_b32 v60, v239, s26, v60 bitop3:0xbe
    v_bitop3_b32 v60, v241, s26, v60 bitop3:0xbe
    v_bitop3_b32 v60, v243, s26, v60 bitop3:0xbe
    v_bitop3_b32 v60, v245, s26, v60 bitop3:0xbe
    v_bitop3_b32 v60, v247, s26, v60 bitop3:0xbe
    v_bitop3_b32 v60, v249, s26, v60 bitop3:0xbe
    v_bitop3_b32 v60, v251, s26, v60 bitop3:0xbe
    v_bitop3_b32 v60, v253, s26, v60 bitop3:0xbe
    v_bitop3_b32 v60, v255, s26, v60 bitop3:0xbe
    v_cmp_ne_u32 vcc, 0, v60
    s_cbranch_vccnz L_gqbf_4
L_gqbd_3:
    v_add_f32 v160, v160, v164
    v_add_f32 v162, v162, v166
    v_add_f32 v184, v184, v188
    v_add_f32 v186, v186, v190
    v_add_f32 v208, v208, v212
    v_add_f32 v210, v210, v214
    v_add_f32 v232, v232, v236
    v_add_f32 v234, v234, v238
    v_add_f32 v160, v160, v168
    v_add_f32 v162, v162, v170
    v_add_f32 v184, v184, v192
    v_add_f32 v186, v186, v194
    v_add_f32 v208, v208, v216
    v_add_f32 v210, v210, v218
    v_add_f32 v232, v232, v240
    v_add_f32 v234, v234, v242
    v_add_f32 v160, v160, v172
    v_add_f32 v162, v162, v174
    v_add_f32 v184, v184, v196
    v_add_f32 v186, v186, v198
    v_add_f32 v208, v208, v220
    v_add_f32 v210, v210, v222
    v_add_f32 v232, v232, v244
    v_add_f32 v234, v234, v246
    v_add_f32 v160, v160, v176
    v_add_f32 v162, v162, v178
    v_add_f32 v184, v184, v200
    v_add_f32 v186, v186, v202
    v_add_f32 v208, v208, v224
    v_add_f32 v210, v210, v226
    v_add_f32 v232, v232, v248
    v_add_f32 v234, v234, v250
    v_add_f32 v160, v160, v180
    v_add_f32 v162, v162, v182
    v_add_f32 v184, v184, v204
    v_add_f32 v186, v186, v206
    v_add_f32 v208, v208, v228
    v_add_f32 v210, v210, v230
    v_add_f32 v232, v232, v252
    v_add_f32 v234, v234, v254
    v_mov_b32 v15, 0
    v_mov_b32 v61, 1
    v_mov_b32 v62, s28
    ds_write_b32 v15, v62 offset:1560
    v_cvt_pk_bf16_f32 v160, v160, v162
    ds_write_b32 v9, v160 offset:0
    v_cvt_pk_bf16_f32 v184, v184, v186
    ds_write_b32 v9, v184 offset:256
    v_cvt_pk_bf16_f32 v208, v208, v210
    ds_write_b32 v9, v208 offset:512
    v_cvt_pk_bf16_f32 v232, v232, v234
    ds_write_b32 v9, v232 offset:768
    ds_write_b32 v15, v61 offset:1536
    s_waitcnt lgkmcnt(0)
    s_lshr_b32 s65, s64, 2
    s_lshl_b32 s3, s7, 2
    s_add_u32 s65, s65, s3
    s_and_b32 s66, s64, 3
    v_bfe_u32 v6, v1, 2, 2
    v_lshl_add_u32 v6, v6, 8, v7
    s_lshl_b32 s3, s65, 7
    s_and_b32 s12, s6, 3
    s_lshl_b32 s12, s12, 5
    s_add_u32 s3, s3, s12
    s_lshr_b32 s12, s6, 2
    s_lshl_b32 s12, s12, 2
    s_add_u32 s3, s3, s12
    s_lshl_b32 s3, s3, 10
    s_and_b32 s12, s66, 1
    s_lshl_b32 s12, s12, 8
    s_add_u32 s3, s3, s12
    s_lshr_b32 s12, s66, 1
    s_lshl_b32 s12, s12, 7
    s_add_u32 s69, s3, s12
    v_bfe_u32 v4, v1, 3, 1
    v_lshlrev_b32 v4, 9, v4
    v_lshl_add_u32 v4, v3, 10, v4
    v_lshl_add_u32 v4, v8, 4, v4
    s_mov_b32 s48, s30
    s_mov_b32 s49, s31
    s_mov_b32 s50, 33554432
    s_mov_b32 s51, 0x20000
    s_mov_b32 s52, s32
    s_mov_b32 s53, s33
    s_mov_b32 s54, 33554432
    s_mov_b32 s55, 0x20000
    s_mov_b32 s56, s36
    s_mov_b32 s57, s37
    s_mov_b32 s58, 4194304
    s_mov_b32 s59, 0x20000
    s_cmp_lt_u32 s64, 16
    s_cselect_b32 s58, s58, 0
    s_mov_b32 s12, 0x830153
    s_bfm_b32 s3, s64, 0
    s_and_b32 s3, s3, s12
    s_bcnt1_i32_b32 s3, s3
    s_lshl_b32 s3, s3, 1
    s_add_u32 s3, s3, 1008
    s_lshl_b32 s3, s3, 12
    s_lshl_b32 s14, s7, 22
    s_bitcmp1_b32 s12, s64
    s_cselect_b32 s50, s50, 0
    s_cselect_b32 s54, s54, 0
    s_cselect_b32 s61, 0, 0xf149f2ca
    s_cselect_b32 s3, s3, 0
    s_add_u32 s14, s14, s3
    s_mov_b32 s15, s14
    buffer_load_dwordx4 v[64:67], v6, s[48:51], s14 offen offset:0 nt
    buffer_load_dwordx4 v[68:71], v6, s[48:51], s14 offen offset:1024 nt
    buffer_load_dwordx4 v[72:75], v6, s[48:51], s14 offen offset:2048 nt
    buffer_load_dwordx4 v[76:79], v6, s[48:51], s14 offen offset:3072 nt
    s_addk_i32 s14, 0x1000
    buffer_load_dwordx4 v[80:83], v6, s[48:51], s14 offen offset:0 nt
    buffer_load_dwordx4 v[84:87], v6, s[48:51], s14 offen offset:1024 nt
    buffer_load_dwordx4 v[88:91], v6, s[48:51], s14 offen offset:2048 nt
    buffer_load_dwordx4 v[92:95], v6, s[48:51], s14 offen offset:3072 nt
    buffer_load_dwordx4 v[160:163], v10, s[52:55], s15 offen offset:0 nt
    buffer_load_dwordx4 v[164:167], v10, s[52:55], s15 offen offset:1024 nt
    buffer_load_dwordx4 v[168:171], v10, s[52:55], s15 offen offset:2048 nt
    buffer_load_dwordx4 v[172:175], v10, s[52:55], s15 offen offset:3072 nt
    s_addk_i32 s15, 0x1000
    buffer_load_dwordx4 v[176:179], v10, s[52:55], s15 offen offset:0 nt
    buffer_load_dwordx4 v[180:183], v10, s[52:55], s15 offen offset:1024 nt
    buffer_load_dwordx4 v[184:187], v10, s[52:55], s15 offen offset:2048 nt
    buffer_load_dwordx4 v[188:191], v10, s[52:55], s15 offen offset:3072 nt
    s_waitcnt vmcnt(0) lgkmcnt(0)
    v_lshrrev_b32 v11, 2, v2
    v_lshl_add_u32 v12, v11, 8, v7
    v_lshlrev_b32 v13, 5, v11
    s_lshl_b32 s3, s6, 2
    v_add_u32 v14, s3, v13
    v_mov_b32 v15, 0
    ds_read_b128 v[16:19], v12 offset:0
    s_waitcnt lgkmcnt(0)
    v_mfma_f32_16x16x32_bf16 v[44:47], v[64:67], v[16:19], 0
    v_mfma_f32_16x16x32_bf16 v[48:51], v[68:71], v[16:19], 0
    v_mfma_f32_16x16x32_bf16 v[52:55], v[72:75], v[16:19], 0
    v_mfma_f32_16x16x32_bf16 v[56:59], v[76:79], v[16:19], 0
    s_nop 4
    v_mov_b32_dpp v64, v44 quad_perm:[0,0,0,0] row_mask:0xf bank_mask:0xf
    v_mov_b32_dpp v65, v48 quad_perm:[0,0,0,0] row_mask:0xf bank_mask:0xf
    v_mov_b32_dpp v66, v52 quad_perm:[0,0,0,0] row_mask:0xf bank_mask:0xf
    v_mov_b32_dpp v67, v56 quad_perm:[0,0,0,0] row_mask:0xf bank_mask:0xf
    v_add_f32_dpp v64, v45, v64 quad_perm:[1,1,1,1] row_mask:0xf bank_mask:0xf
    v_add_f32_dpp v65, v49, v65 quad_perm:[1,1,1,1] row_mask:0xf bank_mask:0xf
    v_add_f32_dpp v66, v53, v66 quad_perm:[1,1,1,1] row_mask:0xf bank_mask:0xf
    v_add_f32_dpp v67, v57, v67 quad_perm:[1,1,1,1] row_mask:0xf bank_mask:0xf
    v_add_f32_dpp v64, v46, v64 quad_perm:[2,2,2,2] row_mask:0xf bank_mask:0xf
    v_add_f32_dpp v65, v50, v65 quad_perm:[2,2,2,2] row_mask:0xf bank_mask:0xf
    v_add_f32_dpp v66, v54, v66 quad_perm:[2,2,2,2] row_mask:0xf bank_mask:0xf
    v_add_f32_dpp v67, v58, v67 quad_perm:[2,2,2,2] row_mask:0xf bank_mask:0xf
    v_add_f32_dpp v64, v47, v64 quad_perm:[3,3,3,3] row_mask:0xf bank_mask:0xf
    v_add_f32_dpp v65, v51, v65 quad_perm:[3,3,3,3] row_mask:0xf bank_mask:0xf
    v_add_f32_dpp v66, v55, v66 quad_perm:[3,3,3,3] row_mask:0xf bank_mask:0xf
    v_add_f32_dpp v67, v59, v67 quad_perm:[3,3,3,3] row_mask:0xf bank_mask:0xf
    v_max3_f32 v60, v64, v65, v66
    v_max_f32 v60, v60, v67
    v_mfma_f32_16x16x32_bf16 v[44:47], v[80:83], v[16:19], 0
    v_mfma_f32_16x16x32_bf16 v[48:51], v[84:87], v[16:19], 0
    v_mfma_f32_16x16x32_bf16 v[52:55], v[88:91], v[16:19], 0
    v_mfma_f32_16x16x32_bf16 v[56:59], v[92:95], v[16:19], 0
    s_nop 4
    v_mov_b32_dpp v80, v44 quad_perm:[0,0,0,0] row_mask:0xf bank_mask:0xf
    v_mov_b32_dpp v81, v48 quad_perm:[0,0,0,0] row_mask:0xf bank_mask:0xf
    v_mov_b32_dpp v82, v52 quad_perm:[0,0,0,0] row_mask:0xf bank_mask:0xf
    v_mov_b32_dpp v83, v56 quad_perm:[0,0,0,0] row_mask:0xf bank_mask:0xf
    v_add_f32_dpp v80, v45, v80 quad_perm:[1,1,1,1] row_mask:0xf bank_mask:0xf
    v_add_f32_dpp v81, v49, v81 quad_perm:[1,1,1,1] row_mask:0xf bank_mask:0xf
    v_add_f32_dpp v82, v53, v82 quad_perm:[1,1,1,1] row_mask:0xf bank_mask:0xf
    v_add_f32_dpp v83, v57, v83 quad_perm:[1,1,1,1] row_mask:0xf bank_mask:0xf
    v_add_f32_dpp v80, v46, v80 quad_perm:[2,2,2,2] row_mask:0xf bank_mask:0xf
    v_add_f32_dpp v81, v50, v81 quad_perm:[2,2,2,2] row_mask:0xf bank_mask:0xf
    v_add_f32_dpp v82, v54, v82 quad_perm:[2,2,2,2] row_mask:0xf bank_mask:0xf
    v_add_f32_dpp v83, v58, v83 quad_perm:[2,2,2,2] row_mask:0xf bank_mask:0xf
    v_add_f32_dpp v80, v47, v80 quad_perm:[3,3,3,3] row_mask:0xf bank_mask:0xf
    v_add_f32_dpp v81, v51, v81 quad_perm:[3,3,3,3] row_mask:0xf bank_mask:0xf
    v_add_f32_dpp v82, v55, v82 quad_perm:[3,3,3,3] row_mask:0xf bank_mask:0xf
    v_add_f32_dpp v83, v59, v83 quad_perm:[3,3,3,3] row_mask:0xf bank_mask:0xf
    v_max3_f32 v60, v60, v80, v81
    v_max3_f32 v60, v60, v82, v83
    v_mov_b32 v61, v60
    s_nop 1
    v_permlane32_swap_b32 v61, v60
    v_max_f32 v60, v61, v60
    v_mov_b32 v61, v60
    s_nop 1
    v_permlane16_swap_b32 v61, v60
    v_max_f32 v60, v61, v60
    v_mul_f32 v62, s60, v60
    v_fma_f32 v64, v64, s60, -v62
    v_fma_f32 v65, v65, s60, -v62
    v_fma_f32 v66, v66, s60, -v62
    v_fma_f32 v67, v67, s60, -v62
    v_exp_f32 v64, v64
    v_exp_f32 v65, v65
    v_exp_f32 v66, v66
    v_exp_f32 v67, v67
    v_add_f32 v63, v64, v65
    v_cvt_pk_bf16_f32 v68, v64, v65
    v_add_f32 v63, v63, v66
    v_cvt_pk_bf16_f32 v69, v66, v67
    v_add_f32 v63, v63, v67
    v_fma_f32 v80, v80, s60, -v62
    v_fma_f32 v81, v81, s60, -v62
    v_fma_f32 v82, v82, s60, -v62
    v_fma_f32 v83, v83, s60, -v62
    v_exp_f32 v80, v80
    v_exp_f32 v81, v81
    v_exp_f32 v82, v82
    v_exp_f32 v83, v83
    v_add_f32 v63, v63, v80
    v_add_f32 v63, v63, v81
    v_cvt_pk_bf16_f32 v84, v80, v81
    v_add_f32 v63, v63, v82
    v_cvt_pk_bf16_f32 v85, v82, v83
    v_add_f32 v63, v63, v83
    v_mov_b32 v61, v63
    s_nop 1
    v_permlane32_swap_b32 v61, v63
    v_add_f32 v63, v61, v63
    v_mov_b32 v61, v63
    s_nop 1
    v_permlane16_swap_b32 v61, v63
    v_add_f32 v63, v61, v63
    v_add_f32 v62, s61, v62
    v_mov_b32 v61, 1
    s_mov_b32 exec_lo, 0x1111
    s_mov_b32 exec_hi, 0x0
    ds_write_b32 v14, v62 offset:1024
    ds_write_b32 v14, v63 offset:1152
    s_mov_b32 exec_lo, 1
    ds_add_u32 v15, v61 offset:1540
    s_mov_b64 exec, -1
    v_perm_b32 v44, v68, v68, v32
    v_perm_b32 v45, v68, v68, v33
    s_nop 1
    v_mfma_f32_16x16x16_bf16 v[24:27], v[44:45], v[160:161], 0
    v_mfma_f32_16x16x16_bf16 v[28:31], v[44:45], v[162:163], 0
    v_perm_b32 v46, v68, v68, v34
    v_perm_b32 v47, v68, v68, v35
    s_nop 1
    v_mfma_f32_16x16x16_bf16 v[24:27], v[46:47], v[164:165], v[24:27]
    v_mfma_f32_16x16x16_bf16 v[28:31], v[46:47], v[166:167], v[28:31]
    v_perm_b32 v48, v69, v69, v32
    v_perm_b32 v49, v69, v69, v33
    s_nop 1
    v_mfma_f32_16x16x16_bf16 v[24:27], v[48:49], v[168:169], v[24:27]
    v_mfma_f32_16x16x16_bf16 v[28:31], v[48:49], v[170:171], v[28:31]
    v_perm_b32 v50, v69, v69, v34
    v_perm_b32 v51, v69, v69, v35
    s_nop 1
    v_mfma_f32_16x16x16_bf16 v[24:27], v[50:51], v[172:173], v[24:27]
    v_mfma_f32_16x16x16_bf16 v[28:31], v[50:51], v[174:175], v[28:31]
    v_perm_b32 v44, v84, v84, v32
    v_perm_b32 v45, v84, v84, v33
    s_nop 1
    v_mfma_f32_16x16x16_bf16 v[24:27], v[44:45], v[176:177], v[24:27]
    v_mfma_f32_16x16x16_bf16 v[28:31], v[44:45], v[178:179], v[28:31]
    v_perm_b32 v46, v84, v84, v34
    v_perm_b32 v47, v84, v84, v35
    s_nop 1
    v_mfma_f32_16x16x16_bf16 v[24:27], v[46:47], v[180:181], v[24:27]
    v_mfma_f32_16x16x16_bf16 v[28:31], v[46:47], v[182:183], v[28:31]
    v_perm_b32 v48, v85, v85, v32
    v_perm_b32 v49, v85, v85, v33
    s_nop 1
    v_mfma_f32_16x16x16_bf16 v[24:27], v[48:49], v[184:185], v[24:27]
    v_mfma_f32_16x16x16_bf16 v[28:31], v[48:49], v[186:187], v[28:31]
    v_perm_b32 v50, v85, v85, v34
    v_perm_b32 v51, v85, v85, v35
    s_nop 1
    v_mfma_f32_16x16x16_bf16 v[24:27], v[50:51], v[188:189], v[24:27]
    v_mfma_f32_16x16x16_bf16 v[28:31], v[50:51], v[190:191], v[28:31]
    s_mul_i32 s68, s65, 12288
    s_lshl_b32 s3, s6, 6
    s_add_u32 s68, s68, s3
    s_add_u32 s68, s68, 786432
    v_and_b32 v9, 3, v1
    v_lshlrev_b32 v9, 4, v9
    v_lshrrev_b32 v6, 2, v1
    v_lshl_add_u32 v6, v6, 9, v9
    v_and_b32 v9, 0xfff, v6
    v_add_u32 v9, 8192, v9
    s_lshl_b32 s12, s7, 11
    s_lshl_b32 s3, s64, 4
    s_add_u32 s12, s12, s3
    s_add_u32 s12, s12, 688128
    v_lshlrev_b32 v11, 4, v13
    v_mov_b32 v53, s25
    v_mov_b32 v55, s25
L_wml_5:
    s_sleep 2
    ds_read_b32 v60, v15 offset:1540
    s_waitcnt lgkmcnt(0)
    v_readfirstlane_b32 s3, v60
    s_nop 0
    s_cmp_lt_u32 s3, 8
    s_cbranch_scc1 L_wml_5
    ds_read_b128 v[128:131], v13 offset:1024
    ds_read_b128 v[132:135], v13 offset:1040
    ds_read_b128 v[136:139], v13 offset:1152
    ds_read_b128 v[140:143], v13 offset:1168
    s_waitcnt lgkmcnt(0)
    v_max3_f32 v52, v128, v129, v130
    v_max3_f32 v52, v52, v131, v132
    v_max3_f32 v52, v52, v133, v134
    v_max_f32 v52, v52, v135
    v_sub_f32 v128, v128, v52
    v_sub_f32 v129, v129, v52
    v_sub_f32 v130, v130, v52
    v_sub_f32 v131, v131, v52
    v_sub_f32 v132, v132, v52
    v_sub_f32 v133, v133, v52
    v_sub_f32 v134, v134, v52
    v_sub_f32 v135, v135, v52
    v_exp_f32 v128, v128
    v_exp_f32 v129, v129
    v_exp_f32 v130, v130
    v_exp_f32 v131, v131
    v_exp_f32 v132, v132
    v_exp_f32 v133, v133
    v_exp_f32 v134, v134
    v_exp_f32 v135, v135
    v_mul_f32 v54, v128, v136
    v_fmac_f32 v54, v129, v137
    v_fmac_f32 v54, v130, v138
    v_fmac_f32 v54, v131, v139
    v_fmac_f32 v54, v132, v140
    v_fmac_f32 v54, v133, v141
    v_fmac_f32 v54, v134, v142
    v_fmac_f32 v54, v135, v143
    s_mov_b32 exec_lo, 0x1111
    s_mov_b32 exec_hi, 0x0
    ds_write_b128 v13, v[128:131] offset:1408
    ds_write_b128 v13, v[132:135] offset:1424
    buffer_store_dwordx4 v[52:55], v11, s[44:47], s12 offen
    s_cmp_eq_u32 s28, 0
    s_cbranch_scc1 L_bml_ns
    s_add_u32 s12, s12, 5242880
    v_mov_b32 v53, s11
    v_mov_b32 v55, s11
    buffer_store_dwordx4 v[52:55], v11, s[44:47], s12 offen sc1
L_bml_ns:
    s_mov_b64 exec, -1
    s_cmp_lt_u32 s64, 16
    s_cbranch_scc0 L_bc_nod
    buffer_load_dwordx4 v[72:75], v4, s[56:59], s69 offen nt
    s_addk_i32 s69, 0x2000
    buffer_load_dwordx4 v[88:91], v4, s[56:59], s69 offen nt
    s_addk_i32 s69, 0x2000
    buffer_load_dwordx4 v[104:107], v4, s[56:59], s69 offen nt
    s_addk_i32 s69, 0x2000
    buffer_load_dwordx4 v[120:123], v4, s[56:59], s69 offen nt
    v_and_b32 v15, 31, v1
    v_min_u32 v11, 23, v15
    v_lshlrev_b32 v11, 4, v11
    s_lshl_b32 s12, s65, 9
    s_add_u32 s12, s12, 688128
    s_mov_b32 s13, 0
    s_mov_b32 s26, s25
L_gml_6:
    buffer_load_dwordx4 v[52:55], v11, s[44:47], s12 offen sc1
    s_add_u32 s13, s13, 1
    s_waitcnt vmcnt(0)
    v_xor_b32 v60, s26, v53
    v_bitop3_b32 v60, v55, s26, v60 bitop3:0xbe
    v_cmp_ne_u32 vcc, 0, v60
    s_cbranch_vccnz L_gmlf_8
L_gmld_7:
    v_mov_b32 v56, v52
    s_nop 1
    v_max_f32_dpp v56, v56, v56 row_ror:8 row_mask:0xf bank_mask:0xf
    s_nop 1
    v_max_f32_dpp v56, v56, v56 row_ror:4 row_mask:0xf bank_mask:0xf
    s_nop 1
    v_max_f32_dpp v56, v56, v56 row_ror:2 row_mask:0xf bank_mask:0xf
    s_nop 1
    v_max_f32_dpp v56, v56, v56 row_ror:1 row_mask:0xf bank_mask:0xf
    v_mov_b32 v57, v56
    s_nop 1
    v_permlane16_swap_b32 v57, v56
    v_max_f32 v56, v57, v56
    v_sub_f32 v52, v52, v56
    v_exp_f32 v52, v52
    v_cmp_gt_u32 vcc, 24, v15
    s_nop 1
    v_cndmask_b32 v52, 0, v52, vcc
    v_mul_f32 v54, v54, v52
    s_nop 1
    v_add_f32_dpp v54, v54, v54 row_ror:8 row_mask:0xf bank_mask:0xf
    s_nop 1
    v_add_f32_dpp v54, v54, v54 row_ror:4 row_mask:0xf bank_mask:0xf
    s_nop 1
    v_add_f32_dpp v54, v54, v54 row_ror:2 row_mask:0xf bank_mask:0xf
    s_nop 1
    v_add_f32_dpp v54, v54, v54 row_ror:1 row_mask:0xf bank_mask:0xf
    v_mov_b32 v57, v54
    s_nop 1
    v_permlane16_swap_b32 v57, v54
    v_add_f32 v54, v57, v54
    v_rcp_f32 v54, v54
    v_lshlrev_b32 v15, 2, v15
    v_mul_f32 v52, v52, v54
    ds_write_b32 v15, v52 offset:1280
L_bc_nod:
    v_perm_b32 v20, -1, -1, v36
    v_perm_b32 v21, -1, -1, v37
    v_perm_b32 v22, -1, -1, v38
    v_perm_b32 v23, -1, -1, v39
    s_lshl_b32 s3, s6, 10
    v_add_u32 v16, s3, v10
    v_and_b32 v17, 31, v1
    v_lshlrev_b32 v17, 4, v17
    v_lshrrev_b32 v12, 5, v1
    v_lshl_add_u32 v17, v12, 12, v17
    s_lshl_b32 s16, s65, 12
    s_lshl_b32 s3, s66, 10
    s_add_u32 s16, s16, s3
    s_add_u32 s16, s16, 1179648
    v_and_b32 v18, 1, v3
    v_lshlrev_b32 v18, 5, v18
    v_lshl_add_u32 v18, v2, 6, v18
    v_lshl_add_u32 v18, v12, 4, v18
    v_mov_b32 v57, s11
    v_mov_b32 v59, s11
    s_lshl_b32 s3, s66, 7
    s_lshl_b32 s14, s65, 2
    s_add_u32 s14, s14, s3
    s_lshl_b32 s17, s14, 3
    s_add_u32 s17, s17, 1179648
    v_lshrrev_b32 v19, 1, v1
    v_lshlrev_b32 v19, 12, v19
    v_and_b32 v15, 1, v1
    v_lshl_add_u32 v19, v15, 4, v19
    s_mov_b32 s48, s38
    s_mov_b32 s49, s39
    s_mov_b32 s50, 2048
    s_mov_b32 s51, 0x20000
    s_lshr_b32 s14, s65, 4
    s_lshl_b32 s14, s14, 8
    s_and_b32 s3, s66, 1
    s_lshl_b32 s3, s3, 7
    s_add_u32 s14, s14, s3
    s_lshr_b32 s3, s66, 1
    s_lshl_b32 s3, s3, 6
    s_add_u32 s14, s14, s3
    s_and_b32 s3, s65, 15
    s_lshl_b32 s3, s3, 2
    s_add_u32 s14, s14, s3
    s_lshl_b32 s14, s14, 1
    s_add_u32 s14, s14, 1024
    v_lshlrev_b32 v15, 2, v15
    v_and_b32 v63, 60, v1
    s_lshl_b32 s3, s6, 11
    v_add_u32 v11, s3, v10
    ds_write_b128 v11, v[24:27] offset:2048
    ds_write_b128 v11, v[28:31] offset:3072
    s_waitcnt lgkmcnt(0)
    s_branch L_btail
L_notctrl:
    s_lshr_b32 s65, s64, 2
    s_lshl_b32 s3, s7, 2
    s_add_u32 s65, s65, s3
    s_and_b32 s66, s64, 3
    v_bfe_u32 v6, v1, 2, 2
    v_lshl_add_u32 v6, v6, 8, v7
    s_lshl_b32 s3, s65, 7
    s_and_b32 s12, s6, 3
    s_lshl_b32 s12, s12, 5
    s_add_u32 s3, s3, s12
    s_lshr_b32 s12, s6, 2
    s_lshl_b32 s12, s12, 2
    s_add_u32 s3, s3, s12
    s_lshl_b32 s3, s3, 10
    s_and_b32 s12, s66, 1
    s_lshl_b32 s12, s12, 8
    s_add_u32 s3, s3, s12
    s_lshr_b32 s12, s66, 1
    s_lshl_b32 s12, s12, 7
    s_add_u32 s69, s3, s12
    v_bfe_u32 v4, v1, 3, 1
    v_lshlrev_b32 v4, 9, v4
    v_lshl_add_u32 v4, v3, 10, v4
    v_lshl_add_u32 v4, v8, 4, v4
    s_mov_b32 s48, s30
    s_mov_b32 s49, s31
    s_mov_b32 s50, 33554432
    s_mov_b32 s51, 0x20000
    s_mov_b32 s52, s32
    s_mov_b32 s53, s33
    s_mov_b32 s54, 33554432
    s_mov_b32 s55, 0x20000
    s_mov_b32 s56, s36
    s_mov_b32 s57, s37
    s_mov_b32 s58, 4194304
    s_mov_b32 s59, 0x20000
    s_cmp_lt_u32 s64, 16
    s_cselect_b32 s58, s58, 0
    s_mul_i32 s3, s64, 7
    s_add_u32 s3, s3, s6
    s_lshl_b32 s3, s3, 12
    s_lshl_b32 s14, s7, 22
    s_add_u32 s14, s14, s3
    s_mov_b32 s15, s14
    s_mov_b32 s67, 688128
    s_mov_b32 s62, 0
    s_mov_b32 s63, -1
    s_mov_b32 s60, 0x3e0293ee
    s_mov_b32 s44, s42
    s_mov_b32 s45, s43
    s_mov_b32 s46, 8388608
    s_mov_b32 s47, 0x20000
    v_and_b32 v15, 3, v0
    v_lshlrev_b32 v15, 4, v15
    v_mov_b32 v13, 0
    v_mov_b32 v11, 0x0c0c0c0c
    v_and_b32 v14, 4, v0
    v_cmp_ne_u32 vcc, 0, v14
    v_mov_b32 v12, 0xd0c
    v_lshlrev_b64 v[32:33], v15, v[12:13]
    v_xor_b32 v32, v11, v32
    v_xor_b32 v33, v11, v33
    v_cndmask_b32 v36, v32, v11, vcc
    v_cndmask_b32 v37, v33, v11, vcc
    v_cndmask_b32 v38, v11, v32, vcc
    v_cndmask_b32 v39, v11, v33, vcc
    v_mov_b32 v12, 0xf0e
    v_lshlrev_b64 v[34:35], v15, v[12:13]
    v_xor_b32 v34, v11, v34
    v_xor_b32 v35, v11, v35
    v_cndmask_b32 v40, v34, v11, vcc
    v_cndmask_b32 v41, v35, v11, vcc
    v_cndmask_b32 v42, v11, v34, vcc
    v_cndmask_b32 v43, v11, v35, vcc
    s_waitcnt vmcnt(3)
    v_perm_b32 v44, v16, v16, v36
    v_perm_b32 v45, v16, v16, v37
    v_perm_b32 v46, v16, v16, v38
    v_perm_b32 v47, v16, v16, v39
    v_perm_b32 v48, v17, v17, v36
    v_perm_b32 v49, v17, v17, v37
    v_perm_b32 v50, v17, v17, v38
    v_perm_b32 v51, v17, v17, v39
    v_perm_b32 v52, v18, v18, v36
    v_perm_b32 v53, v18, v18, v37
    v_perm_b32 v54, v18, v18, v38
    v_perm_b32 v55, v18, v18, v39
    v_mfma_f32_16x16x32_bf16 v[152:155], v[44:47], v[128:131], 0
    v_mfma_f32_16x16x32_bf16 v[152:155], v[48:51], v[132:135], v[152:155]
    v_mfma_f32_16x16x32_bf16 v[152:155], v[52:55], v[136:139], v[152:155]
    v_lshlrev_b32 v11, 4, v0
    s_nop 6
    ds_write_b128 v11, v[152:155] offset:32768
    s_waitcnt lgkmcnt(0)
    s_barrier
    ds_read_b32 v12, v13 offset:1544
    s_mov_b32 s16, s34
    s_mov_b32 s17, s35
    s_mov_b32 s18, 4194304
    s_mov_b32 s19, 0x20000
    buffer_load_dwordx4 v[140:143], v22, s[16:19], 0 offen nt
    v_add_u32 v22, 0x40000, v22
    buffer_load_dwordx4 v[144:147], v22, s[16:19], 0 offen nt
    v_add_u32 v22, 0x40000, v22
    buffer_load_dwordx4 v[148:151], v22, s[16:19], 0 offen nt
    s_waitcnt lgkmcnt(0)
    v_readfirstlane_b32 s11, v12
    s_getreg_b32 s24, hwreg(HW_REG_XCC_ID, 0, 4)
    s_xor_b32 s25, s11, s24
    s_waitcnt vmcnt(0)
    v_perm_b32 v44, v19, v19, v36
    v_perm_b32 v45, v19, v19, v37
    v_perm_b32 v46, v19, v19, v38
    v_perm_b32 v47, v19, v19, v39
    v_perm_b32 v48, v20, v20, v36
    v_perm_b32 v49, v20, v20, v37
    v_perm_b32 v50, v20, v20, v38
    v_perm_b32 v51, v20, v20, v39
    v_perm_b32 v52, v21, v21, v36
    v_perm_b32 v53, v21, v21, v37
    v_perm_b32 v54, v21, v21, v38
    v_perm_b32 v55, v21, v21, v39
    v_mfma_f32_16x16x32_bf16 v[152:155], v[44:47], v[140:143], 0
    v_mfma_f32_16x16x32_bf16 v[152:155], v[48:51], v[144:147], v[152:155]
    v_mfma_f32_16x16x32_bf16 v[152:155], v[52:55], v[148:151], v[152:155]
    v_lshlrev_b32 v11, 4, v0
    s_nop 6
    ds_write_b128 v11, v[152:155] offset:49152
    v_mov_b32 v12, 1
    s_mov_b64 exec, 1
    ds_add_u32 v13, v12 offset:1548
    s_mov_b64 exec, -1
    s_barrier
    buffer_load_dwordx4 v[64:67], v6, s[48:51], s14 offen offset:0 nt
    buffer_load_dwordx4 v[68:71], v6, s[48:51], s14 offen offset:1024 nt
    buffer_load_dwordx4 v[72:75], v6, s[48:51], s14 offen offset:2048 nt
    s_waitcnt vmcnt(2)
    buffer_load_dwordx4 v[76:79], v6, s[48:51], s14 offen offset:3072 nt
    s_waitcnt vmcnt(2)
    s_add_u32 s14, s14, s67
    buffer_load_dwordx4 v[80:83], v6, s[48:51], s14 offen offset:0 nt
    s_waitcnt vmcnt(2)
    buffer_load_dwordx4 v[84:87], v6, s[48:51], s14 offen offset:1024 nt
    s_waitcnt vmcnt(2)
    buffer_load_dwordx4 v[88:91], v6, s[48:51], s14 offen offset:2048 nt
    s_waitcnt vmcnt(2)
    buffer_load_dwordx4 v[92:95], v6, s[48:51], s14 offen offset:3072 nt
    s_waitcnt vmcnt(2)
    s_add_u32 s14, s14, s67
    buffer_load_dwordx4 v[96:99], v6, s[48:51], s14 offen offset:0 nt
    s_waitcnt vmcnt(2)
    buffer_load_dwordx4 v[100:103], v6, s[48:51], s14 offen offset:1024 nt
    s_waitcnt vmcnt(2)
    buffer_load_dwordx4 v[104:107], v6, s[48:51], s14 offen offset:2048 nt
    s_waitcnt vmcnt(2)
    buffer_load_dwordx4 v[108:111], v6, s[48:51], s14 offen offset:3072 nt
    s_waitcnt vmcnt(2)
    s_add_u32 s14, s14, s67
    buffer_load_dwordx4 v[112:115], v6, s[48:51], s14 offen offset:0 nt
    s_waitcnt vmcnt(2)
    buffer_load_dwordx4 v[116:119], v6, s[48:51], s14 offen offset:1024 nt
    s_waitcnt vmcnt(2)
    buffer_load_dwordx4 v[120:123], v6, s[48:51], s14 offen offset:2048 nt
    s_waitcnt vmcnt(2)
    buffer_load_dwordx4 v[124:127], v6, s[48:51], s14 offen offset:3072 nt
    s_waitcnt vmcnt(2)
    s_add_u32 s14, s14, s67
    buffer_load_dwordx4 v[128:131], v6, s[48:51], s14 offen offset:0 nt
    s_waitcnt vmcnt(2)
    buffer_load_dwordx4 v[132:135], v6, s[48:51], s14 offen offset:1024 nt
    s_waitcnt vmcnt(2)
    buffer_load_dwordx4 v[136:139], v6, s[48:51], s14 offen offset:2048 nt
    s_waitcnt vmcnt(2)
    buffer_load_dwordx4 v[140:143], v6, s[48:51], s14 offen offset:3072 nt
    s_waitcnt vmcnt(4)
    s_add_u32 s14, s14, s67
    buffer_load_dwordx4 v[144:147], v6, s[48:51], s14 offen offset:0 nt
    v_lshrrev_b32 v11, 2, v2
    v_lshl_add_u32 v12, v11, 8, v7
    v_lshlrev_b32 v13, 5, v11
    s_lshl_b32 s3, s6, 2
    v_add_u32 v14, s3, v13
    v_mov_b32 v15, 0
L_wq_9:
    ds_read_b32 v60, v15 offset:1536
    s_waitcnt lgkmcnt(0)
    v_readfirstlane_b32 s3, v60
    s_nop 0
    s_cmp_eq_u32 s3, 0
    s_cbranch_scc1 L_wq_9
    ds_read_b128 v[16:19], v12 offset:0
    s_waitcnt lgkmcnt(0)
    v_mfma_f32_16x16x32_bf16 v[44:47], v[64:67], v[16:19], 0
    v_mfma_f32_16x16x32_bf16 v[48:51], v[68:71], v[16:19], 0
    v_mfma_f32_16x16x32_bf16 v[52:55], v[72:75], v[16:19], 0
    v_mfma_f32_16x16x32_bf16 v[56:59], v[76:79], v[16:19], 0
    s_nop 4
    v_mov_b32_dpp v64, v44 quad_perm:[0,0,0,0] row_mask:0xf bank_mask:0xf
    v_mov_b32_dpp v65, v48 quad_perm:[0,0,0,0] row_mask:0xf bank_mask:0xf
    v_mov_b32_dpp v66, v52 quad_perm:[0,0,0,0] row_mask:0xf bank_mask:0xf
    v_mov_b32_dpp v67, v56 quad_perm:[0,0,0,0] row_mask:0xf bank_mask:0xf
    v_add_f32_dpp v64, v45, v64 quad_perm:[1,1,1,1] row_mask:0xf bank_mask:0xf
    v_add_f32_dpp v65, v49, v65 quad_perm:[1,1,1,1] row_mask:0xf bank_mask:0xf
    v_add_f32_dpp v66, v53, v66 quad_perm:[1,1,1,1] row_mask:0xf bank_mask:0xf
    v_add_f32_dpp v67, v57, v67 quad_perm:[1,1,1,1] row_mask:0xf bank_mask:0xf
    v_add_f32_dpp v64, v46, v64 quad_perm:[2,2,2,2] row_mask:0xf bank_mask:0xf
    v_add_f32_dpp v65, v50, v65 quad_perm:[2,2,2,2] row_mask:0xf bank_mask:0xf
    v_add_f32_dpp v66, v54, v66 quad_perm:[2,2,2,2] row_mask:0xf bank_mask:0xf
    v_add_f32_dpp v67, v58, v67 quad_perm:[2,2,2,2] row_mask:0xf bank_mask:0xf
    v_add_f32_dpp v64, v47, v64 quad_perm:[3,3,3,3] row_mask:0xf bank_mask:0xf
    v_add_f32_dpp v65, v51, v65 quad_perm:[3,3,3,3] row_mask:0xf bank_mask:0xf
    v_add_f32_dpp v66, v55, v66 quad_perm:[3,3,3,3] row_mask:0xf bank_mask:0xf
    v_add_f32_dpp v67, v59, v67 quad_perm:[3,3,3,3] row_mask:0xf bank_mask:0xf
    v_max3_f32 v60, v64, v65, v66
    v_max_f32 v60, v60, v67
    v_mfma_f32_16x16x32_bf16 v[44:47], v[80:83], v[16:19], 0
    v_mfma_f32_16x16x32_bf16 v[48:51], v[84:87], v[16:19], 0
    v_mfma_f32_16x16x32_bf16 v[52:55], v[88:91], v[16:19], 0
    v_mfma_f32_16x16x32_bf16 v[56:59], v[92:95], v[16:19], 0
    s_nop 4
    v_mov_b32_dpp v80, v44 quad_perm:[0,0,0,0] row_mask:0xf bank_mask:0xf
    v_mov_b32_dpp v81, v48 quad_perm:[0,0,0,0] row_mask:0xf bank_mask:0xf
    v_mov_b32_dpp v82, v52 quad_perm:[0,0,0,0] row_mask:0xf bank_mask:0xf
    v_mov_b32_dpp v83, v56 quad_perm:[0,0,0,0] row_mask:0xf bank_mask:0xf
    v_add_f32_dpp v80, v45, v80 quad_perm:[1,1,1,1] row_mask:0xf bank_mask:0xf
    v_add_f32_dpp v81, v49, v81 quad_perm:[1,1,1,1] row_mask:0xf bank_mask:0xf
    v_add_f32_dpp v82, v53, v82 quad_perm:[1,1,1,1] row_mask:0xf bank_mask:0xf
    v_add_f32_dpp v83, v57, v83 quad_perm:[1,1,1,1] row_mask:0xf bank_mask:0xf
    v_add_f32_dpp v80, v46, v80 quad_perm:[2,2,2,2] row_mask:0xf bank_mask:0xf
    v_add_f32_dpp v81, v50, v81 quad_perm:[2,2,2,2] row_mask:0xf bank_mask:0xf
    v_add_f32_dpp v82, v54, v82 quad_perm:[2,2,2,2] row_mask:0xf bank_mask:0xf
    v_add_f32_dpp v83, v58, v83 quad_perm:[2,2,2,2] row_mask:0xf bank_mask:0xf
    v_add_f32_dpp v80, v47, v80 quad_perm:[3,3,3,3] row_mask:0xf bank_mask:0xf
    v_add_f32_dpp v81, v51, v81 quad_perm:[3,3,3,3] row_mask:0xf bank_mask:0xf
    v_add_f32_dpp v82, v55, v82 quad_perm:[3,3,3,3] row_mask:0xf bank_mask:0xf
    v_add_f32_dpp v83, v59, v83 quad_perm:[3,3,3,3] row_mask:0xf bank_mask:0xf
    v_max3_f32 v60, v60, v80, v81
    v_max3_f32 v60, v60, v82, v83
    s_waitcnt vmcnt(4)
    buffer_load_dwordx4 v[148:151], v6, s[48:51], s14 offen offset:1024 nt
    v_mfma_f32_16x16x32_bf16 v[44:47], v[96:99], v[16:19], 0
    v_mfma_f32_16x16x32_bf16 v[48:51], v[100:103], v[16:19], 0
    v_mfma_f32_16x16x32_bf16 v[52:55], v[104:107], v[16:19], 0
    v_mfma_f32_16x16x32_bf16 v[56:59], v[108:111], v[16:19], 0
    s_nop 4
    v_mov_b32_dpp v96, v44 quad_perm:[0,0,0,0] row_mask:0xf bank_mask:0xf
    v_mov_b32_dpp v97, v48 quad_perm:[0,0,0,0] row_mask:0xf bank_mask:0xf
    v_mov_b32_dpp v98, v52 quad_perm:[0,0,0,0] row_mask:0xf bank_mask:0xf
    v_mov_b32_dpp v99, v56 quad_perm:[0,0,0,0] row_mask:0xf bank_mask:0xf
    v_add_f32_dpp v96, v45, v96 quad_perm:[1,1,1,1] row_mask:0xf bank_mask:0xf
    v_add_f32_dpp v97, v49, v97 quad_perm:[1,1,1,1] row_mask:0xf bank_mask:0xf
    v_add_f32_dpp v98, v53, v98 quad_perm:[1,1,1,1] row_mask:0xf bank_mask:0xf
    v_add_f32_dpp v99, v57, v99 quad_perm:[1,1,1,1] row_mask:0xf bank_mask:0xf
    v_add_f32_dpp v96, v46, v96 quad_perm:[2,2,2,2] row_mask:0xf bank_mask:0xf
    v_add_f32_dpp v97, v50, v97 quad_perm:[2,2,2,2] row_mask:0xf bank_mask:0xf
    v_add_f32_dpp v98, v54, v98 quad_perm:[2,2,2,2] row_mask:0xf bank_mask:0xf
    v_add_f32_dpp v99, v58, v99 quad_perm:[2,2,2,2] row_mask:0xf bank_mask:0xf
    v_add_f32_dpp v96, v47, v96 quad_perm:[3,3,3,3] row_mask:0xf bank_mask:0xf
    v_add_f32_dpp v97, v51, v97 quad_perm:[3,3,3,3] row_mask:0xf bank_mask:0xf
    v_add_f32_dpp v98, v55, v98 quad_perm:[3,3,3,3] row_mask:0xf bank_mask:0xf
    v_add_f32_dpp v99, v59, v99 quad_perm:[3,3,3,3] row_mask:0xf bank_mask:0xf
    v_max3_f32 v60, v60, v96, v97
    v_max3_f32 v60, v60, v98, v99
    v_mfma_f32_16x16x32_bf16 v[44:47], v[112:115], v[16:19], 0
    v_mfma_f32_16x16x32_bf16 v[48:51], v[116:119], v[16:19], 0
    v_mfma_f32_16x16x32_bf16 v[52:55], v[120:123], v[16:19], 0
    v_mfma_f32_16x16x32_bf16 v[56:59], v[124:127], v[16:19], 0
    s_nop 4
    v_mov_b32_dpp v112, v44 quad_perm:[0,0,0,0] row_mask:0xf bank_mask:0xf
    v_mov_b32_dpp v113, v48 quad_perm:[0,0,0,0] row_mask:0xf bank_mask:0xf
    v_mov_b32_dpp v114, v52 quad_perm:[0,0,0,0] row_mask:0xf bank_mask:0xf
    v_mov_b32_dpp v115, v56 quad_perm:[0,0,0,0] row_mask:0xf bank_mask:0xf
    v_add_f32_dpp v112, v45, v112 quad_perm:[1,1,1,1] row_mask:0xf bank_mask:0xf
    v_add_f32_dpp v113, v49, v113 quad_perm:[1,1,1,1] row_mask:0xf bank_mask:0xf
    v_add_f32_dpp v114, v53, v114 quad_perm:[1,1,1,1] row_mask:0xf bank_mask:0xf
    v_add_f32_dpp v115, v57, v115 quad_perm:[1,1,1,1] row_mask:0xf bank_mask:0xf
    v_add_f32_dpp v112, v46, v112 quad_perm:[2,2,2,2] row_mask:0xf bank_mask:0xf
    v_add_f32_dpp v113, v50, v113 quad_perm:[2,2,2,2] row_mask:0xf bank_mask:0xf
    v_add_f32_dpp v114, v54, v114 quad_perm:[2,2,2,2] row_mask:0xf bank_mask:0xf
    v_add_f32_dpp v115, v58, v115 quad_perm:[2,2,2,2] row_mask:0xf bank_mask:0xf
    v_add_f32_dpp v112, v47, v112 quad_perm:[3,3,3,3] row_mask:0xf bank_mask:0xf
    v_add_f32_dpp v113, v51, v113 quad_perm:[3,3,3,3] row_mask:0xf bank_mask:0xf
    v_add_f32_dpp v114, v55, v114 quad_perm:[3,3,3,3] row_mask:0xf bank_mask:0xf
    v_add_f32_dpp v115, v59, v115 quad_perm:[3,3,3,3] row_mask:0xf bank_mask:0xf
    v_max3_f32 v60, v60, v112, v113
    v_max3_f32 v60, v60, v114, v115
    s_waitcnt vmcnt(4)
    buffer_load_dwordx4 v[152:155], v6, s[48:51], s14 offen offset:2048 nt
    s_waitcnt vmcnt(4)
    buffer_load_dwordx4 v[156:159], v6, s[48:51], s14 offen offset:3072 nt
    s_waitcnt vmcnt(4)
    buffer_load_dwordx4 v[160:163], v10, s[52:55], s15 offen offset:0 nt
    v_mfma_f32_16x16x32_bf16 v[44:47], v[128:131], v[16:19], 0
    v_mfma_f32_16x16x32_bf16 v[48:51], v[132:135], v[16:19], 0
    v_mfma_f32_16x16x32_bf16 v[52:55], v[136:139], v[16:19], 0
    v_mfma_f32_16x16x32_bf16 v[56:59], v[140:143], v[16:19], 0
    s_nop 4
    v_mov_b32_dpp v128, v44 quad_perm:[0,0,0,0] row_mask:0xf bank_mask:0xf
    v_mov_b32_dpp v129, v48 quad_perm:[0,0,0,0] row_mask:0xf bank_mask:0xf
    v_mov_b32_dpp v130, v52 quad_perm:[0,0,0,0] row_mask:0xf bank_mask:0xf
    v_mov_b32_dpp v131, v56 quad_perm:[0,0,0,0] row_mask:0xf bank_mask:0xf
    v_add_f32_dpp v128, v45, v128 quad_perm:[1,1,1,1] row_mask:0xf bank_mask:0xf
    v_add_f32_dpp v129, v49, v129 quad_perm:[1,1,1,1] row_mask:0xf bank_mask:0xf
    v_add_f32_dpp v130, v53, v130 quad_perm:[1,1,1,1] row_mask:0xf bank_mask:0xf
    v_add_f32_dpp v131, v57, v131 quad_perm:[1,1,1,1] row_mask:0xf bank_mask:0xf
    v_add_f32_dpp v128, v46, v128 quad_perm:[2,2,2,2] row_mask:0xf bank_mask:0xf
    v_add_f32_dpp v129, v50, v129 quad_perm:[2,2,2,2] row_mask:0xf bank_mask:0xf
    v_add_f32_dpp v130, v54, v130 quad_perm:[2,2,2,2] row_mask:0xf bank_mask:0xf
    v_add_f32_dpp v131, v58, v131 quad_perm:[2,2,2,2] row_mask:0xf bank_mask:0xf
    v_add_f32_dpp v128, v47, v128 quad_perm:[3,3,3,3] row_mask:0xf bank_mask:0xf
    v_add_f32_dpp v129, v51, v129 quad_perm:[3,3,3,3] row_mask:0xf bank_mask:0xf
    v_add_f32_dpp v130, v55, v130 quad_perm:[3,3,3,3] row_mask:0xf bank_mask:0xf
    v_add_f32_dpp v131, v59, v131 quad_perm:[3,3,3,3] row_mask:0xf bank_mask:0xf
    v_max3_f32 v60, v60, v128, v129
    v_max3_f32 v60, v60, v130, v131
    s_waitcnt vmcnt(4)
    buffer_load_dwordx4 v[164:167], v10, s[52:55], s15 offen offset:1024 nt
    s_waitcnt vmcnt(4)
    buffer_load_dwordx4 v[168:171], v10, s[52:55], s15 offen offset:2048 nt
    s_waitcnt vmcnt(4)
    buffer_load_dwordx4 v[172:175], v10, s[52:55], s15 offen offset:3072 nt
    s_waitcnt vmcnt(4)
    s_add_u32 s15, s15, s67
    buffer_load_dwordx4 v[176:179], v10, s[52:55], s15 offen offset:0 nt
    v_mfma_f32_16x16x32_bf16 v[44:47], v[144:147], v[16:19], 0
    v_mfma_f32_16x16x32_bf16 v[48:51], v[148:151], v[16:19], 0
    v_mfma_f32_16x16x32_bf16 v[52:55], v[152:155], v[16:19], 0
    v_mfma_f32_16x16x32_bf16 v[56:59], v[156:159], v[16:19], 0
    s_nop 4
    v_mov_b32_dpp v144, v44 quad_perm:[0,0,0,0] row_mask:0xf bank_mask:0xf
    v_mov_b32_dpp v145, v48 quad_perm:[0,0,0,0] row_mask:0xf bank_mask:0xf
    v_mov_b32_dpp v146, v52 quad_perm:[0,0,0,0] row_mask:0xf bank_mask:0xf
    v_mov_b32_dpp v147, v56 quad_perm:[0,0,0,0] row_mask:0xf bank_mask:0xf
    v_add_f32_dpp v144, v45, v144 quad_perm:[1,1,1,1] row_mask:0xf bank_mask:0xf
    v_add_f32_dpp v145, v49, v145 quad_perm:[1,1,1,1] row_mask:0xf bank_mask:0xf
    v_add_f32_dpp v146, v53, v146 quad_perm:[1,1,1,1] row_mask:0xf bank_mask:0xf
    v_add_f32_dpp v147, v57, v147 quad_perm:[1,1,1,1] row_mask:0xf bank_mask:0xf
    v_add_f32_dpp v144, v46, v144 quad_perm:[2,2,2,2] row_mask:0xf bank_mask:0xf
    v_add_f32_dpp v145, v50, v145 quad_perm:[2,2,2,2] row_mask:0xf bank_mask:0xf
    v_add_f32_dpp v146, v54, v146 quad_perm:[2,2,2,2] row_mask:0xf bank_mask:0xf
    v_add_f32_dpp v147, v58, v147 quad_perm:[2,2,2,2] row_mask:0xf bank_mask:0xf
    v_add_f32_dpp v144, v47, v144 quad_perm:[3,3,3,3] row_mask:0xf bank_mask:0xf
    v_add_f32_dpp v145, v51, v145 quad_perm:[3,3,3,3] row_mask:0xf bank_mask:0xf
    v_add_f32_dpp v146, v55, v146 quad_perm:[3,3,3,3] row_mask:0xf bank_mask:0xf
    v_add_f32_dpp v147, v59, v147 quad_perm:[3,3,3,3] row_mask:0xf bank_mask:0xf
    v_max3_f32 v60, v60, v144, v145
    v_max3_f32 v60, v60, v146, v147
    v_mov_b32 v61, v60
    s_nop 1
    v_permlane32_swap_b32 v61, v60
    v_max_f32 v60, v61, v60
    v_mov_b32 v61, v60
    s_nop 1
    v_permlane16_swap_b32 v61, v60
    v_max_f32 v60, v61, v60
    v_mul_f32 v62, s60, v60
    v_fma_f32 v64, v64, s60, -v62
    v_fma_f32 v65, v65, s60, -v62
    v_fma_f32 v66, v66, s60, -v62
    v_fma_f32 v67, v67, s60, -v62
    v_exp_f32 v64, v64
    v_exp_f32 v65, v65
    v_exp_f32 v66, v66
    v_exp_f32 v67, v67
    v_add_f32 v63, v64, v65
    v_cvt_pk_bf16_f32 v68, v64, v65
    v_add_f32 v63, v63, v66
    v_cvt_pk_bf16_f32 v69, v66, v67
    v_add_f32 v63, v63, v67
    s_waitcnt vmcnt(4)
    buffer_load_dwordx4 v[180:183], v10, s[52:55], s15 offen offset:1024 nt
    v_fma_f32 v80, v80, s60, -v62
    v_fma_f32 v81, v81, s60, -v62
    v_fma_f32 v82, v82, s60, -v62
    v_fma_f32 v83, v83, s60, -v62
    v_exp_f32 v80, v80
    v_exp_f32 v81, v81
    v_exp_f32 v82, v82
    v_exp_f32 v83, v83
    v_add_f32 v63, v63, v80
    v_add_f32 v63, v63, v81
    v_cvt_pk_bf16_f32 v84, v80, v81
    v_add_f32 v63, v63, v82
    v_cvt_pk_bf16_f32 v85, v82, v83
    v_add_f32 v63, v63, v83
    v_fma_f32 v96, v96, s60, -v62
    v_fma_f32 v97, v97, s60, -v62
    v_fma_f32 v98, v98, s60, -v62
    v_fma_f32 v99, v99, s60, -v62
    v_exp_f32 v96, v96
    v_exp_f32 v97, v97
    v_exp_f32 v98, v98
    v_exp_f32 v99, v99
    v_add_f32 v63, v63, v96
    v_add_f32 v63, v63, v97
    v_cvt_pk_bf16_f32 v100, v96, v97
    v_add_f32 v63, v63, v98
    v_cvt_pk_bf16_f32 v101, v98, v99
    v_add_f32 v63, v63, v99
    v_fma_f32 v112, v112, s60, -v62
    v_fma_f32 v113, v113, s60, -v62
    v_fma_f32 v114, v114, s60, -v62
    v_fma_f32 v115, v115, s60, -v62
    v_exp_f32 v112, v112
    v_exp_f32 v113, v113
    v_exp_f32 v114, v114
    v_exp_f32 v115, v115
    v_add_f32 v63, v63, v112
    v_add_f32 v63, v63, v113
    v_cvt_pk_bf16_f32 v116, v112, v113
    v_add_f32 v63, v63, v114
    v_cvt_pk_bf16_f32 v117, v114, v115
    v_add_f32 v63, v63, v115
    s_mul_i32 s68, s65, 12288
    s_lshl_b32 s3, s6, 6
    s_add_u32 s68, s68, s3
    s_add_u32 s68, s68, 786432
    v_and_b32 v9, 3, v1
    v_lshlrev_b32 v9, 4, v9
    v_lshrrev_b32 v6, 2, v1
    v_lshl_add_u32 v6, v6, 9, v9
    v_and_b32 v9, 0xfff, v6
    v_add_u32 v9, 8192, v9
    s_waitcnt vmcnt(4)
    buffer_load_dwordx4 v[184:187], v10, s[52:55], s15 offen offset:2048 nt
    v_fma_f32 v128, v128, s60, -v62
    v_fma_f32 v129, v129, s60, -v62
    v_fma_f32 v130, v130, s60, -v62
    v_fma_f32 v131, v131, s60, -v62
    v_exp_f32 v128, v128
    v_exp_f32 v129, v129
    v_exp_f32 v130, v130
    v_exp_f32 v131, v131
    v_add_f32 v63, v63, v128
    v_add_f32 v63, v63, v129
    v_cvt_pk_bf16_f32 v132, v128, v129
    v_add_f32 v63, v63, v130
    v_cvt_pk_bf16_f32 v133, v130, v131
    v_add_f32 v63, v63, v131
    v_fma_f32 v144, v144, s60, -v62
    v_fma_f32 v145, v145, s60, -v62
    v_fma_f32 v146, v146, s60, -v62
    v_fma_f32 v147, v147, s60, -v62
    v_exp_f32 v144, v144
    v_exp_f32 v145, v145
    v_exp_f32 v146, v146
    v_exp_f32 v147, v147
    v_add_f32 v63, v63, v144
    v_add_f32 v63, v63, v145
    v_cvt_pk_bf16_f32 v148, v144, v145
    v_add_f32 v63, v63, v146
    v_cvt_pk_bf16_f32 v149, v146, v147
    v_add_f32 v63, v63, v147
    v_mov_b32 v61, v63
    s_nop 1
    v_permlane32_swap_b32 v61, v63
    v_add_f32 v63, v61, v63
    v_mov_b32 v61, v63
    s_nop 1
    v_permlane16_swap_b32 v61, v63
    v_add_f32 v63, v61, v63
    v_mov_b32 v61, 1
    s_mov_b32 exec_lo, 0x1111
    s_mov_b32 exec_hi, 0x0
    ds_write_b32 v14, v62 offset:1024
    ds_write_b32 v14, v63 offset:1152
    s_mov_b32 exec_lo, 1
    ds_add_u32 v15, v61 offset:1540
    s_mov_b64 exec, -1
    v_perm_b32 v44, v68, v68, v32
    v_perm_b32 v45, v68, v68, v33
    s_nop 1
    v_mfma_f32_16x16x16_bf16 v[24:27], v[44:45], v[160:161], 0
    v_mfma_f32_16x16x16_bf16 v[28:31], v[44:45], v[162:163], 0
    v_perm_b32 v46, v68, v68, v34
    v_perm_b32 v47, v68, v68, v35
    s_nop 1
    v_mfma_f32_16x16x16_bf16 v[24:27], v[46:47], v[164:165], v[24:27]
    v_mfma_f32_16x16x16_bf16 v[28:31], v[46:47], v[166:167], v[28:31]
    s_waitcnt vmcnt(4)
    buffer_load_dwordx4 v[188:191], v10, s[52:55], s15 offen offset:3072 nt
    v_perm_b32 v48, v69, v69, v32
    v_perm_b32 v49, v69, v69, v33
    s_nop 1
    v_mfma_f32_16x16x16_bf16 v[24:27], v[48:49], v[168:169], v[24:27]
    v_mfma_f32_16x16x16_bf16 v[28:31], v[48:49], v[170:171], v[28:31]
    s_waitcnt vmcnt(4)
    s_add_u32 s15, s15, s67
    buffer_load_dwordx4 v[192:195], v10, s[52:55], s15 offen offset:0 nt
    v_perm_b32 v50, v69, v69, v34
    v_perm_b32 v51, v69, v69, v35
    s_nop 1
    v_mfma_f32_16x16x16_bf16 v[24:27], v[50:51], v[172:173], v[24:27]
    v_mfma_f32_16x16x16_bf16 v[28:31], v[50:51], v[174:175], v[28:31]
    s_waitcnt vmcnt(4)
    buffer_load_dwordx4 v[196:199], v10, s[52:55], s15 offen offset:1024 nt
    v_perm_b32 v44, v84, v84, v32
    v_perm_b32 v45, v84, v84, v33
    s_nop 1
    v_mfma_f32_16x16x16_bf16 v[24:27], v[44:45], v[176:177], v[24:27]
    v_mfma_f32_16x16x16_bf16 v[28:31], v[44:45], v[178:179], v[28:31]
    s_waitcnt vmcnt(4)
    buffer_load_dwordx4 v[200:203], v10, s[52:55], s15 offen offset:2048 nt
    v_perm_b32 v46, v84, v84, v34
    v_perm_b32 v47, v84, v84, v35
    s_nop 1
    v_mfma_f32_16x16x16_bf16 v[24:27], v[46:47], v[180:181], v[24:27]
    v_mfma_f32_16x16x16_bf16 v[28:31], v[46:47], v[182:183], v[28:31]
    s_waitcnt vmcnt(4)
    buffer_load_dwordx4 v[204:207], v10, s[52:55], s15 offen offset:3072 nt
    v_perm_b32 v48, v85, v85, v32
    v_perm_b32 v49, v85, v85, v33
    s_nop 1
    v_mfma_f32_16x16x16_bf16 v[24:27], v[48:49], v[184:185], v[24:27]
    v_mfma_f32_16x16x16_bf16 v[28:31], v[48:49], v[186:187], v[28:31]
    s_waitcnt vmcnt(4)
    s_add_u32 s15, s15, s67
    buffer_load_dwordx4 v[208:211], v10, s[52:55], s15 offen offset:0 nt
    v_perm_b32 v50, v85, v85, v34
    v_perm_b32 v51, v85, v85, v35
    s_nop 1
    v_mfma_f32_16x16x16_bf16 v[24:27], v[50:51], v[188:189], v[24:27]
    v_mfma_f32_16x16x16_bf16 v[28:31], v[50:51], v[190:191], v[28:31]
    s_waitcnt vmcnt(4)
    buffer_load_dwordx4 v[212:215], v10, s[52:55], s15 offen offset:1024 nt
    v_perm_b32 v44, v100, v100, v32
    v_perm_b32 v45, v100, v100, v33
    s_nop 1
    v_mfma_f32_16x16x16_bf16 v[24:27], v[44:45], v[192:193], v[24:27]
    v_mfma_f32_16x16x16_bf16 v[28:31], v[44:45], v[194:195], v[28:31]
    s_waitcnt vmcnt(11)
    buffer_load_dwordx4 v[216:219], v10, s[52:55], s15 offen offset:2048 nt
    s_waitcnt vmcnt(11)
    buffer_load_dwordx4 v[220:223], v10, s[52:55], s15 offen offset:3072 nt
    s_waitcnt vmcnt(11)
    s_add_u32 s15, s15, s67
    buffer_load_dwordx4 v[224:227], v10, s[52:55], s15 offen offset:0 nt
    s_waitcnt vmcnt(11)
    buffer_load_dwordx4 v[228:231], v10, s[52:55], s15 offen offset:1024 nt
    s_waitcnt vmcnt(11)
    buffer_load_dwordx4 v[232:235], v10, s[52:55], s15 offen offset:2048 nt
    s_waitcnt vmcnt(11)
    buffer_load_dwordx4 v[236:239], v10, s[52:55], s15 offen offset:3072 nt
    s_waitcnt vmcnt(11)
    s_add_u32 s15, s15, s67
    buffer_load_dwordx4 v[240:243], v10, s[52:55], s15 offen offset:0 nt
    s_waitcnt vmcnt(11)
    buffer_load_dwordx4 v[244:247], v10, s[52:55], s15 offen offset:1024 nt
    v_perm_b32 v46, v100, v100, v34
    v_perm_b32 v47, v100, v100, v35
    s_nop 1
    v_mfma_f32_16x16x16_bf16 v[24:27], v[46:47], v[196:197], v[24:27]
    v_mfma_f32_16x16x16_bf16 v[28:31], v[46:47], v[198:199], v[28:31]
    s_waitcnt vmcnt(11)
    buffer_load_dwordx4 v[248:251], v10, s[52:55], s15 offen offset:2048 nt
    v_perm_b32 v48, v101, v101, v32
    v_perm_b32 v49, v101, v101, v33
    s_nop 1
    v_mfma_f32_16x16x16_bf16 v[24:27], v[48:49], v[200:201], v[24:27]
    v_mfma_f32_16x16x16_bf16 v[28:31], v[48:49], v[202:203], v[28:31]
    s_waitcnt vmcnt(11)
    buffer_load_dwordx4 v[252:255], v10, s[52:55], s15 offen offset:3072 nt
    v_perm_b32 v50, v101, v101, v34
    v_perm_b32 v51, v101, v101, v35
    s_nop 1
    v_mfma_f32_16x16x16_bf16 v[24:27], v[50:51], v[204:205], v[24:27]
    v_mfma_f32_16x16x16_bf16 v[28:31], v[50:51], v[206:207], v[28:31]
    v_perm_b32 v20, -1, -1, v36
    v_perm_b32 v21, -1, -1, v37
    v_perm_b32 v22, -1, -1, v38
    v_perm_b32 v23, -1, -1, v39
    s_lshl_b32 s3, s6, 10
    v_add_u32 v16, s3, v10
    v_and_b32 v17, 31, v1
    v_lshlrev_b32 v17, 4, v17
    v_lshrrev_b32 v12, 5, v1
    v_lshl_add_u32 v17, v12, 12, v17
    s_lshl_b32 s16, s65, 12
    s_lshl_b32 s3, s66, 10
    s_add_u32 s16, s16, s3
    s_add_u32 s16, s16, 1179648
    v_and_b32 v18, 1, v3
    v_lshlrev_b32 v18, 5, v18
    v_lshl_add_u32 v18, v2, 6, v18
    v_lshl_add_u32 v18, v12, 4, v18
    v_mov_b32 v57, s11
    v_mov_b32 v59, s11
    s_lshl_b32 s3, s66, 7
    s_lshl_b32 s14, s65, 2
    s_add_u32 s14, s14, s3
    s_lshl_b32 s17, s14, 3
    s_add_u32 s17, s17, 1179648
    v_lshrrev_b32 v19, 1, v1
    v_lshlrev_b32 v19, 12, v19
    v_and_b32 v15, 1, v1
    v_lshl_add_u32 v19, v15, 4, v19
    s_mov_b32 s48, s38
    s_mov_b32 s49, s39
    s_mov_b32 s50, 2048
    s_mov_b32 s51, 0x20000
    s_lshr_b32 s14, s65, 4
    s_lshl_b32 s14, s14, 8
    s_and_b32 s3, s66, 1
    s_lshl_b32 s3, s3, 7
    s_add_u32 s14, s14, s3
    s_lshr_b32 s3, s66, 1
    s_lshl_b32 s3, s3, 6
    s_add_u32 s14, s14, s3
    s_and_b32 s3, s65, 15
    s_lshl_b32 s3, s3, 2
    s_add_u32 s14, s14, s3
    s_lshl_b32 s14, s14, 1
    s_add_u32 s14, s14, 1024
    v_lshlrev_b32 v15, 2, v15
    v_and_b32 v63, 60, v1
    v_perm_b32 v44, v116, v116, v32
    v_perm_b32 v45, v116, v116, v33
    s_waitcnt vmcnt(11)
    s_nop 0
    v_mfma_f32_16x16x16_bf16 v[24:27], v[44:45], v[208:209], v[24:27]
    v_mfma_f32_16x16x16_bf16 v[28:31], v[44:45], v[210:211], v[28:31]
    v_perm_b32 v46, v116, v116, v34
    v_perm_b32 v47, v116, v116, v35
    s_waitcnt vmcnt(10)
    s_nop 0
    v_mfma_f32_16x16x16_bf16 v[24:27], v[46:47], v[212:213], v[24:27]
    v_mfma_f32_16x16x16_bf16 v[28:31], v[46:47], v[214:215], v[28:31]
    v_perm_b32 v48, v117, v117, v32
    v_perm_b32 v49, v117, v117, v33
    s_waitcnt vmcnt(9)
    s_nop 0
    v_mfma_f32_16x16x16_bf16 v[24:27], v[48:49], v[216:217], v[24:27]
    v_mfma_f32_16x16x16_bf16 v[28:31], v[48:49], v[218:219], v[28:31]
    v_perm_b32 v50, v117, v117, v34
    v_perm_b32 v51, v117, v117, v35
    s_waitcnt vmcnt(8)
    s_nop 0
    v_mfma_f32_16x16x16_bf16 v[24:27], v[50:51], v[220:221], v[24:27]
    v_mfma_f32_16x16x16_bf16 v[28:31], v[50:51], v[222:223], v[28:31]
    v_perm_b32 v44, v132, v132, v32
    v_perm_b32 v45, v132, v132, v33
    s_waitcnt vmcnt(7)
    s_nop 0
    v_mfma_f32_16x16x16_bf16 v[24:27], v[44:45], v[224:225], v[24:27]
    v_mfma_f32_16x16x16_bf16 v[28:31], v[44:45], v[226:227], v[28:31]
    v_perm_b32 v46, v132, v132, v34
    v_perm_b32 v47, v132, v132, v35
    s_waitcnt vmcnt(6)
    s_nop 0
    v_mfma_f32_16x16x16_bf16 v[24:27], v[46:47], v[228:229], v[24:27]
    v_mfma_f32_16x16x16_bf16 v[28:31], v[46:47], v[230:231], v[28:31]
    v_perm_b32 v48, v133, v133, v32
    v_perm_b32 v49, v133, v133, v33
    s_waitcnt vmcnt(5)
    s_nop 0
    v_mfma_f32_16x16x16_bf16 v[24:27], v[48:49], v[232:233], v[24:27]
    v_mfma_f32_16x16x16_bf16 v[28:31], v[48:49], v[234:235], v[28:31]
    v_perm_b32 v50, v133, v133, v34
    v_perm_b32 v51, v133, v133, v35
    s_waitcnt vmcnt(4)
    s_nop 0
    v_mfma_f32_16x16x16_bf16 v[24:27], v[50:51], v[236:237], v[24:27]
    v_mfma_f32_16x16x16_bf16 v[28:31], v[50:51], v[238:239], v[28:31]
    v_perm_b32 v44, v148, v148, v32
    v_perm_b32 v45, v148, v148, v33
    s_waitcnt vmcnt(3)
    s_nop 0
    v_mfma_f32_16x16x16_bf16 v[24:27], v[44:45], v[240:241], v[24:27]
    v_mfma_f32_16x16x16_bf16 v[28:31], v[44:45], v[242:243], v[28:31]
    v_perm_b32 v46, v148, v148, v34
    v_perm_b32 v47, v148, v148, v35
    s_waitcnt vmcnt(2)
    s_nop 0
    v_mfma_f32_16x16x16_bf16 v[24:27], v[46:47], v[244:245], v[24:27]
    v_mfma_f32_16x16x16_bf16 v[28:31], v[46:47], v[246:247], v[28:31]
    v_perm_b32 v48, v149, v149, v32
    v_perm_b32 v49, v149, v149, v33
    s_waitcnt vmcnt(1)
    s_nop 0
    v_mfma_f32_16x16x16_bf16 v[24:27], v[48:49], v[248:249], v[24:27]
    v_mfma_f32_16x16x16_bf16 v[28:31], v[48:49], v[250:251], v[28:31]
    v_perm_b32 v50, v149, v149, v34
    v_perm_b32 v51, v149, v149, v35
    s_waitcnt vmcnt(0)
    s_cmp_lt_u32 s6, 4
    s_cbranch_scc0 L_wol_10
    buffer_load_dwordx4 v[72:75], v4, s[56:59], s69 offen nt
    s_addk_i32 s69, 0x2000
    buffer_load_dwordx4 v[88:91], v4, s[56:59], s69 offen nt
    s_addk_i32 s69, 0x2000
    buffer_load_dwordx4 v[104:107], v4, s[56:59], s69 offen nt
    s_addk_i32 s69, 0x2000
    buffer_load_dwordx4 v[120:123], v4, s[56:59], s69 offen nt
L_wol_10:
    v_mfma_f32_16x16x16_bf16 v[24:27], v[50:51], v[252:253], v[24:27]
    v_mfma_f32_16x16x16_bf16 v[28:31], v[50:51], v[254:255], v[28:31]
    s_lshl_b32 s3, s6, 11
    v_add_u32 v11, s3, v10
    s_nop 4
    ds_write_b128 v11, v[24:27] offset:2048
    ds_write_b128 v11, v[28:31] offset:3072
    s_waitcnt lgkmcnt(0)
    s_branch L_btail
L_btail:
    s_barrier
    s_cmp_lt_u32 s6, 2
    s_cbranch_scc0 L_bt_nored
    s_lshl_b32 s3, s6, 10
    v_add_u32 v11, s3, v10
    v_lshlrev_b32 v13, 5, v3
    v_mov_b32 v12, 0
    ds_read_b32 v62, v12 offset:1560
    ds_read_b128 v[44:47], v13 offset:1408
    ds_read_b128 v[48:51], v13 offset:1424
    ds_read_b128 v[128:131], v11 offset:2048
    ds_read_b128 v[132:135], v11 offset:4096
    ds_read_b128 v[136:139], v11 offset:6144
    ds_read_b128 v[140:143], v11 offset:8192
    ds_read_b128 v[144:147], v11 offset:10240
    ds_read_b128 v[148:151], v11 offset:12288
    ds_read_b128 v[152:155], v11 offset:14336
    ds_read_b128 v[156:159], v11 offset:16384
    s_mul_i32 s15, s7, 49152
    s_lshl_b32 s3, s64, 9
    s_add_u32 s15, s15, s3
    s_lshl_b32 s3, s6, 8
    s_add_u32 s15, s15, s3
    s_add_u32 s15, s15, 786432
    v_mul_u32_u24 v14, 12288, v3
    v_lshl_add_u32 v14, v2, 4, v14
    v_mov_b32 v53, s25
    v_mov_b32 v55, s25
    s_waitcnt lgkmcnt(7)
    v_pk_mul_f32 v[128:129], v[128:129], v[44:45] op_sel:[0,0] op_sel_hi:[1,0]
    v_pk_mul_f32 v[130:131], v[130:131], v[44:45] op_sel:[0,0] op_sel_hi:[1,0]
    s_waitcnt lgkmcnt(6)
    v_pk_fma_f32 v[128:129], v[132:133], v[44:45], v[128:129] op_sel:[0,1,0] op_sel_hi:[1,1,1]
    v_pk_fma_f32 v[130:131], v[134:135], v[44:45], v[130:131] op_sel:[0,1,0] op_sel_hi:[1,1,1]
    s_waitcnt lgkmcnt(5)
    v_pk_fma_f32 v[128:129], v[136:137], v[46:47], v[128:129] op_sel:[0,0,0] op_sel_hi:[1,0,1]
    v_pk_fma_f32 v[130:131], v[138:139], v[46:47], v[130:131] op_sel:[0,0,0] op_sel_hi:[1,0,1]
    s_waitcnt lgkmcnt(4)
    v_pk_fma_f32 v[128:129], v[140:141], v[46:47], v[128:129] op_sel:[0,1,0] op_sel_hi:[1,1,1]
    v_pk_fma_f32 v[130:131], v[142:143], v[46:47], v[130:131] op_sel:[0,1,0] op_sel_hi:[1,1,1]
    s_waitcnt lgkmcnt(3)
    v_pk_fma_f32 v[128:129], v[144:145], v[48:49], v[128:129] op_sel:[0,0,0] op_sel_hi:[1,0,1]
    v_pk_fma_f32 v[130:131], v[146:147], v[48:49], v[130:131] op_sel:[0,0,0] op_sel_hi:[1,0,1]
    s_waitcnt lgkmcnt(2)
    v_pk_fma_f32 v[128:129], v[148:149], v[48:49], v[128:129] op_sel:[0,1,0] op_sel_hi:[1,1,1]
    v_pk_fma_f32 v[130:131], v[150:151], v[48:49], v[130:131] op_sel:[0,1,0] op_sel_hi:[1,1,1]
    s_waitcnt lgkmcnt(1)
    v_pk_fma_f32 v[128:129], v[152:153], v[50:51], v[128:129] op_sel:[0,0,0] op_sel_hi:[1,0,1]
    v_pk_fma_f32 v[130:131], v[154:155], v[50:51], v[130:131] op_sel:[0,0,0] op_sel_hi:[1,0,1]
    s_waitcnt lgkmcnt(0)
    v_pk_fma_f32 v[128:129], v[156:157], v[50:51], v[128:129] op_sel:[0,1,0] op_sel_hi:[1,1,1]
    v_pk_fma_f32 v[130:131], v[158:159], v[50:51], v[130:131] op_sel:[0,1,0] op_sel_hi:[1,1,1]
    v_cvt_pk_bf16_f32 v52, v128, v129
    v_cvt_pk_bf16_f32 v54, v130, v131
    buffer_store_dwordx4 v[52:55], v14, s[44:47], s15 offen
    v_readfirstlane_b32 s3, v62
    s_nop 0
    s_cmp_eq_u32 s3, 0
    s_cbranch_scc1 L_bt_nored
    s_add_u32 s15, s15, 5242880
    v_mov_b32 v53, s11
    v_mov_b32 v55, s11
    buffer_store_dwordx4 v[52:55], v14, s[44:47], s15 offen sc1
L_bt_nored:
    s_cmp_lt_u32 s64, 16
    s_cbranch_scc1 L_bt_duty
    s_endpgm
L_bt_duty:
    s_barrier
    s_sub_u32 s3, s6, 4
    s_cmp_lt_u32 s3, 3
    s_cbranch_scc0 L_wol_11
    buffer_load_dwordx4 v[72:75], v4, s[56:59], s69 offen nt
    s_addk_i32 s69, 0x2000
    buffer_load_dwordx4 v[88:91], v4, s[56:59], s69 offen nt
    s_addk_i32 s69, 0x2000
    buffer_load_dwordx4 v[104:107], v4, s[56:59], s69 offen nt
    s_addk_i32 s69, 0x2000
    buffer_load_dwordx4 v[120:123], v4, s[56:59], s69 offen nt
L_wol_11:
    s_mov_b32 s13, 0
    s_mov_b32 s26, s25
    buffer_load_dwordx4 v[128:131], v6, s[44:47], s68 offen sc1
    buffer_load_dwordx4 v[132:135], v9, s[44:47], s68 offen sc1
    ds_read_b32 v60, v63 offset:1280
    ds_read_b32 v61, v63 offset:1344
    s_waitcnt lgkmcnt(0)
    s_branch L_gbow_15
L_gbo_12:
    buffer_load_dwordx4 v[128:131], v6, s[44:47], s68 offen sc1
    buffer_load_dwordx4 v[132:135], v9, s[44:47], s68 offen sc1
L_gbow_15:
    s_add_u32 s13, s13, 1
    s_waitcnt vmcnt(0)
    v_xor_b32 v62, s26, v129
    v_bitop3_b32 v62, v131, s26, v62 bitop3:0xbe
    v_bitop3_b32 v62, v133, s26, v62 bitop3:0xbe
    v_bitop3_b32 v62, v135, s26, v62 bitop3:0xbe
    v_cmp_ne_u32 vcc, 0, v62
    s_cbranch_vccnz L_gbof_14
L_gbod_13:
    v_lshlrev_b32 v136, 16, v128
    v_and_b32 v137, 0xffff0000, v128
    v_lshlrev_b32 v138, 16, v130
    v_and_b32 v139, 0xffff0000, v130
    v_mul_f32 v140, v60, v136
    v_mul_f32 v141, v60, v137
    v_mul_f32 v142, v60, v138
    v_mul_f32 v143, v60, v139
    v_lshlrev_b32 v136, 16, v132
    v_and_b32 v137, 0xffff0000, v132
    v_lshlrev_b32 v138, 16, v134
    v_and_b32 v139, 0xffff0000, v134
    v_fmac_f32 v140, v61, v136
    v_fmac_f32 v141, v61, v137
    v_fmac_f32 v142, v61, v138
    v_fmac_f32 v143, v61, v139
    s_nop 0
    v_permlane32_swap_b32 v140, v142
    v_permlane32_swap_b32 v141, v143
    v_add_f32 v140, v140, v142
    v_add_f32 v141, v141, v143
    s_nop 1
    v_permlane16_swap_b32 v140, v141
    v_add_f32 v140, v140, v141
    s_nop 1
    v_add_f32_dpp v140, v140, v140 row_ror:8 row_mask:0xf bank_mask:0xf
    s_nop 1
    v_add_f32_dpp v140, v140, v140 row_ror:4 row_mask:0xf bank_mask:0xf
    v_cvt_pk_bf16_f32 v140, v140, v140
    s_nop 1
    v_and_b32_dpp v148, v140, v20 quad_perm:[0,0,0,0] row_mask:0xf bank_mask:0xf
    v_and_b32_dpp v149, v140, v21 quad_perm:[0,0,0,0] row_mask:0xf bank_mask:0xf
    v_and_b32_dpp v150, v140, v22 quad_perm:[0,0,0,0] row_mask:0xf bank_mask:0xf
    v_and_b32_dpp v151, v140, v23 quad_perm:[0,0,0,0] row_mask:0xf bank_mask:0xf
    v_and_b32_dpp v152, v140, v20 quad_perm:[1,1,1,1] row_mask:0xf bank_mask:0xf
    v_and_b32_dpp v153, v140, v21 quad_perm:[1,1,1,1] row_mask:0xf bank_mask:0xf
    v_and_b32_dpp v154, v140, v22 quad_perm:[1,1,1,1] row_mask:0xf bank_mask:0xf
    v_and_b32_dpp v155, v140, v23 quad_perm:[1,1,1,1] row_mask:0xf bank_mask:0xf
    v_mfma_f32_16x16x32_bf16 v[24:27], v[148:151], v[72:75], 0
    v_and_b32_dpp v156, v140, v20 quad_perm:[2,2,2,2] row_mask:0xf bank_mask:0xf
    v_and_b32_dpp v157, v140, v21 quad_perm:[2,2,2,2] row_mask:0xf bank_mask:0xf
    v_and_b32_dpp v158, v140, v22 quad_perm:[2,2,2,2] row_mask:0xf bank_mask:0xf
    v_and_b32_dpp v159, v140, v23 quad_perm:[2,2,2,2] row_mask:0xf bank_mask:0xf
    v_mfma_f32_16x16x32_bf16 v[24:27], v[152:155], v[88:91], v[24:27]
    v_and_b32_dpp v160, v140, v20 quad_perm:[3,3,3,3] row_mask:0xf bank_mask:0xf
    v_and_b32_dpp v161, v140, v21 quad_perm:[3,3,3,3] row_mask:0xf bank_mask:0xf
    v_and_b32_dpp v162, v140, v22 quad_perm:[3,3,3,3] row_mask:0xf bank_mask:0xf
    v_and_b32_dpp v163, v140, v23 quad_perm:[3,3,3,3] row_mask:0xf bank_mask:0xf
    v_mfma_f32_16x16x32_bf16 v[24:27], v[156:159], v[104:107], v[24:27]
    s_nop 0
    v_mfma_f32_16x16x32_bf16 v[24:27], v[160:163], v[120:123], v[24:27]
    s_nop 7
    ds_write_b128 v16, v[24:27] offset:20480
    s_waitcnt lgkmcnt(0)
    s_barrier
    s_cmp_eq_u32 s6, 0
    s_cbranch_scc1 L_bt_fin
    s_endpgm
L_bt_fin:
    ds_read_b128 v[128:131], v17 offset:20480
    ds_read_b128 v[132:135], v17 offset:21504
    ds_read_b128 v[136:139], v17 offset:22528
    ds_read_b128 v[140:143], v17 offset:23552
    s_waitcnt lgkmcnt(2)
    v_pk_add_f32 v[128:129], v[128:129], v[132:133]
    v_pk_add_f32 v[130:131], v[130:131], v[134:135]
    s_waitcnt lgkmcnt(1)
    v_pk_add_f32 v[128:129], v[128:129], v[136:137]
    v_pk_add_f32 v[130:131], v[130:131], v[138:139]
    s_waitcnt lgkmcnt(0)
    v_pk_add_f32 v[128:129], v[128:129], v[140:141]
    v_pk_add_f32 v[130:131], v[130:131], v[142:143]
    s_nop 1
    v_permlane32_swap_b32 v128, v130
    v_permlane32_swap_b32 v129, v131
    v_add_f32 v56, v128, v130
    v_add_f32 v58, v129, v131
    buffer_store_dwordx4 v[56:59], v18, s[44:47], s16 offen sc1
    s_mov_b32 s13, 0
L_gob_16:
    buffer_load_dwordx4 v[128:131], v19, s[44:47], s17 offen sc1
    s_add_u32 s13, s13, 1
    s_waitcnt vmcnt(0)
    v_xor_b32 v62, s11, v129
    v_bitop3_b32 v62, v131, s11, v62 bitop3:0xbe
    v_cmp_ne_u32 vcc, 0, v62
    s_cmp_gt_u32 s13, 400000
    s_cbranch_scc1 L_gobd_17
    s_cbranch_vccnz L_gob_16
L_gobd_17:
    v_add_f32_dpp v128, v128, v128 row_ror:8 row_mask:0xf bank_mask:0xf
    v_add_f32_dpp v130, v130, v130 row_ror:8 row_mask:0xf bank_mask:0xf
    s_nop 0
    v_add_f32_dpp v128, v128, v128 row_ror:4 row_mask:0xf bank_mask:0xf
    v_add_f32_dpp v130, v130, v130 row_ror:4 row_mask:0xf bank_mask:0xf
    s_nop 0
    v_add_f32_dpp v128, v128, v128 row_ror:2 row_mask:0xf bank_mask:0xf
    v_add_f32_dpp v130, v130, v130 row_ror:2 row_mask:0xf bank_mask:0xf
    v_mov_b32 v144, v128
    v_mov_b32 v145, v130
    s_nop 0
    v_permlane32_swap_b32 v144, v128
    v_permlane32_swap_b32 v145, v130
    v_add_f32 v128, v144, v128
    v_add_f32 v130, v145, v130
    v_mov_b32 v144, v128
    v_mov_b32 v145, v130
    s_nop 0
    v_permlane16_swap_b32 v144, v128
    v_permlane16_swap_b32 v145, v130
    v_add_f32 v128, v144, v128
    v_add_f32 v130, v145, v130
    v_cvt_pk_bf16_f32 v146, v128, v130
    s_mov_b32 exec_lo, 0x3
    s_mov_b32 exec_hi, 0x0
    buffer_store_dword v146, v15, s[48:51], s14 offen
    s_endpgm
L_astream:
    s_lshl_b32 s64, s7, 3
    s_add_u32 s64, s64, s8
    s_lshr_b32 s65, s64, 1
    s_and_b32 s66, s64, 1
    s_lshl_b32 s14, s64, 13
    s_lshl_b32 s3, s6, 10
    s_add_u32 s14, s14, s3
    s_mov_b32 s61, 0x80000
    s_lshl_b32 s15, s6, 13
    s_add_u32 s15, s15, 589824
    s_lshl_b32 s67, s6, 14
    v_and_b32 v11, 3, v2
    v_lshlrev_b32 v11, 2, v11
    v_lshrrev_b32 v12, 2, v2
    v_and_b32 v13, 1, v12
    v_or_b32 v11, v11, v13
    v_xor_b32 v12, v12, v2
    v_and_b32 v12, 2, v12
    v_or_b32 v11, v11, v12
    v_lshlrev_b32 v11, 4, v11
    v_lshl_add_u32 v11, v3, 8, v11
    v_lshl_add_u32 v11, v2, 10, v11
    v_add_u32 v6, s67, v11
    v_add_u32 v7, 131072, v11
    v_add_u32 v9, s67, v10
    s_waitcnt lgkmcnt(0)
    s_load_dword s11, s[42:43], 0
    s_mov_b32 s48, s18
    s_mov_b32 s49, s19
    s_mov_b32 s50, 16777216
    s_mov_b32 s51, 0x20000
    buffer_load_dwordx4 v[64:67], v10, s[48:51], s14 offen nt
    s_add_u32 s14, s14, s61
    buffer_load_dwordx4 v[68:71], v10, s[48:51], s14 offen nt
    s_add_u32 s14, s14, s61
    buffer_load_dwordx4 v[72:75], v10, s[48:51], s14 offen nt
    s_add_u32 s14, s14, s61
    buffer_load_dwordx4 v[76:79], v10, s[48:51], s14 offen nt
    s_add_u32 s14, s14, s61
L_arest:
    s_mov_b32 s62, 0
    s_mov_b32 s63, -1
    s_mov_b32 s60, 0x3e0293ee
    s_mov_b32 s44, s42
    s_mov_b32 s45, s43
    s_mov_b32 s46, 8388608
    s_mov_b32 s47, 0x20000
    v_and_b32 v15, 3, v0
    v_lshlrev_b32 v15, 4, v15
    v_mov_b32 v13, 0
    v_mov_b32 v11, 0x0c0c0c0c
    v_and_b32 v14, 4, v0
    v_cmp_ne_u32 vcc, 0, v14
    v_mov_b32 v12, 0xd0c
    v_lshlrev_b64 v[32:33], v15, v[12:13]
    v_xor_b32 v32, v11, v32
    v_xor_b32 v33, v11, v33
    v_cndmask_b32 v36, v32, v11, vcc
    v_cndmask_b32 v37, v33, v11, vcc
    v_cndmask_b32 v38, v11, v32, vcc
    v_cndmask_b32 v39, v11, v33, vcc
    v_mov_b32 v12, 0xf0e
    v_lshlrev_b64 v[34:35], v15, v[12:13]
    v_xor_b32 v34, v11, v34
    v_xor_b32 v35, v11, v35
    v_cndmask_b32 v40, v34, v11, vcc
    v_cndmask_b32 v41, v35, v11, vcc
    v_cndmask_b32 v42, v11, v34, vcc
    v_cndmask_b32 v43, v11, v35, vcc
    v_lshlrev_b32 v250, 5, v2
    s_lshl_b32 s3, s6, 2
    v_add_u32 v250, 147456, v250
    v_add_u32 v251, s3, v250
    v_lshrrev_b32 v252, 1, v3
    s_lshl_b32 s3, s6, 1
    v_add_u32 v252, s3, v252
    v_xor_b32 v252, v252, v2
    v_lshlrev_b32 v252, 4, v252
    v_lshl_add_u32 v252, v2, 9, v252
    v_and_b32 v56, 1, v3
    v_lshl_add_u32 v252, v56, 3, v252
    v_add_u32 v252, 131072, v252
    v_and_b32 v14, 31, v1
    v_lshrrev_b32 v15, 5, v1
    v_xor_b32 v253, v15, v2
    v_lshlrev_b32 v253, 4, v253
    v_lshl_add_u32 v253, v14, 9, v253
    v_add_u32 v253, 131072, v253
    v_bfe_u32 v57, v1, 2, 2
    v_lshlrev_b32 v58, 2, v57
    v_lshrrev_b32 v59, 1, v57
    v_xor_b32 v59, v59, v15
    v_lshl_add_u32 v58, v59, 1, v58
    v_bfe_u32 v59, v1, 1, 1
    v_lshl_add_u32 v59, v56, 1, v59
    s_and_b32 s3, s6, 1
    s_lshl_b32 s3, s3, 3
    v_add_u32 v59, s3, v59
    v_xor_b32 v58, v58, v59
    v_lshlrev_b32 v58, 4, v58
    v_and_b32 v59, 1, v1
    v_lshl_add_u32 v58, v59, 3, v58
    v_lshl_add_u32 v58, v57, 10, v58
    v_lshl_add_u32 v58, v15, 13, v58
    s_lshr_b32 s3, s6, 1
    s_lshl_b32 s3, s3, 8
    v_add_u32 v32, s3, v58
    v_xor_b32 v33, 16, v32
    v_add_u32 v33, 0x1000, v33
    v_xor_b32 v34, 64, v32
    v_xor_b32 v35, 64, v33
    v_and_b32 v254, 7, v14
    v_lshlrev_b32 v254, 4, v254
    v_lshl_add_u32 v254, v14, 10, v254
    v_lshl_add_u32 v254, v15, 3, v254
    s_lshl_b32 s3, s6, 7
    v_add_u32 v254, s3, v254
    s_and_b32 s3, s6, 1
    s_lshl_b32 s3, s3, 6
    v_xor_b32 v255, s3, v10
    s_lshl_b32 s3, s6, 12
    v_add_u32 v255, s3, v255
    v_lshlrev_b32 v4, 3, v1
    s_lshl_b32 s3, s6, 12
    s_add_u32 s3, s3, 131072
    v_add_u32 v4, s3, v4
    s_and_b32 s3, s6, 3
    s_lshl_b32 s3, s3, 4
    v_xor_b32 v4, s3, v4
    s_lshl_b32 s16, s6, 18
    s_lshl_b32 s3, s64, 10
    s_add_u32 s16, s16, s3
    s_add_u32 s16, s16, 2097152
    s_mov_b32 s17, 0x10000
    s_mov_b32 s52, s24
    s_mov_b32 s53, s25
    s_mov_b32 s54, 4194304
    s_mov_b32 s55, 0x20000
    s_mov_b32 s56, s26
    s_mov_b32 s57, s27
    s_mov_b32 s58, 4194304
    s_mov_b32 s59, 0x20000
    s_lshl_b32 s68, s6, 19
    s_lshl_b32 s3, s65, 8
    s_add_u32 s68, s68, s3
    s_lshl_b32 s3, s66, 7
    s_add_u32 s68, s68, s3
    v_bfe_u32 v248, v1, 3, 1
    v_lshlrev_b32 v248, 16, v248
    v_lshl_add_u32 v248, v3, 17, v248
    v_lshl_add_u32 v248, v8, 4, v248
    s_lshl_b32 s69, s64, 16
    s_lshr_b32 s3, s6, 2
    s_lshl_b32 s3, s3, 15
    s_add_u32 s69, s69, s3
    s_and_b32 s3, s6, 3
    s_lshl_b32 s3, s3, 8
    s_add_u32 s69, s69, s3
    v_lshlrev_b32 v249, 13, v3
    v_lshl_add_u32 v249, v2, 4, v249
    s_waitcnt lgkmcnt(0)
    s_mul_i32 s11, s11, 0x9e3779b1
    s_add_u32 s11, s11, 0x7f4a7c15
    s_waitcnt vmcnt(3)
    buffer_load_dwordx4 v[80:83], v10, s[48:51], s14 offen nt
    s_add_u32 s14, s14, s61
    v_xor_b32 v12, 0, v9
    ds_write_b128 v12, v[64:67] offset:0
    s_waitcnt vmcnt(3)
    buffer_load_dwordx4 v[84:87], v10, s[48:51], s14 offen nt
    s_add_u32 s14, s14, s61
    v_xor_b32 v12, 64, v9
    ds_write_b128 v12, v[68:71] offset:1024
    s_waitcnt vmcnt(4)
    buffer_load_dwordx4 v[88:91], v10, s[48:51], s14 offen nt
    s_add_u32 s14, s14, s61
    s_waitcnt vmcnt(4)
    buffer_load_dwordx4 v[92:95], v10, s[48:51], s14 offen nt
    s_add_u32 s14, s14, s61
    v_xor_b32 v12, 160, v9
    ds_write_b128 v12, v[72:75] offset:2048
    s_waitcnt vmcnt(4)
    buffer_load_dwordx4 v[96:99], v10, s[48:51], s14 offen nt
    s_add_u32 s14, s14, s61
    v_xor_b32 v12, 224, v9
    ds_write_b128 v12, v[76:79] offset:3072
    s_waitcnt vmcnt(4)
    buffer_load_dwordx4 v[100:103], v10, s[48:51], s14 offen nt
    s_add_u32 s14, s14, s61
    v_xor_b32 v12, 16, v9
    ds_write_b128 v12, v[80:83] offset:4096
    s_waitcnt vmcnt(4)
    buffer_load_dwordx4 v[104:107], v10, s[48:51], s14 offen nt
    s_add_u32 s14, s14, s61
    v_xor_b32 v12, 80, v9
    ds_write_b128 v12, v[84:87] offset:5120
    s_waitcnt vmcnt(4)
    buffer_load_dwordx4 v[108:111], v10, s[48:51], s14 offen nt
    s_add_u32 s14, s14, s61
    v_xor_b32 v12, 176, v9
    ds_write_b128 v12, v[88:91] offset:6144
    s_waitcnt vmcnt(4)
    buffer_load_dwordx4 v[112:115], v10, s[48:51], s14 offen nt
    s_add_u32 s14, s14, s61
    v_xor_b32 v12, 240, v9
    ds_write_b128 v12, v[92:95] offset:7168
    s_waitcnt vmcnt(4)
    buffer_load_dwordx4 v[116:119], v10, s[48:51], s14 offen nt
    s_add_u32 s14, s14, s61
    v_xor_b32 v12, 32, v9
    ds_write_b128 v12, v[96:99] offset:8192
    s_waitcnt vmcnt(4)
    buffer_load_dwordx4 v[120:123], v10, s[48:51], s14 offen nt
    s_add_u32 s14, s14, s61
    v_xor_b32 v12, 96, v9
    ds_write_b128 v12, v[100:103] offset:9216
    s_waitcnt vmcnt(4)
    buffer_load_dwordx4 v[124:127], v10, s[48:51], s14 offen nt
    s_add_u32 s14, s14, s61
    v_xor_b32 v12, 128, v9
    ds_write_b128 v12, v[104:107] offset:10240
    s_waitcnt vmcnt(4)
    buffer_load_dwordx4 v[128:131], v10, s[48:51], s14 offen nt
    s_add_u32 s14, s14, s61
    v_xor_b32 v12, 192, v9
    ds_write_b128 v12, v[108:111] offset:11264
    s_waitcnt vmcnt(4)
    buffer_load_dwordx4 v[132:135], v10, s[48:51], s14 offen nt
    s_add_u32 s14, s14, s61
    v_xor_b32 v12, 48, v9
    ds_write_b128 v12, v[112:115] offset:12288
    s_waitcnt vmcnt(4)
    buffer_load_dwordx4 v[136:139], v10, s[48:51], s14 offen nt
    s_add_u32 s14, s14, s61
    v_xor_b32 v12, 112, v9
    ds_write_b128 v12, v[116:119] offset:13312
    s_waitcnt vmcnt(4)
    buffer_load_dwordx4 v[140:143], v10, s[48:51], s14 offen nt
    s_add_u32 s14, s14, s61
    v_xor_b32 v12, 144, v9
    ds_write_b128 v12, v[120:123] offset:14336
    s_waitcnt vmcnt(4)
    buffer_load_dwordx4 v[144:147], v10, s[48:51], s14 offen nt
    s_add_u32 s14, s14, s61
    v_xor_b32 v12, 208, v9
    ds_write_b128 v12, v[124:127] offset:15360
    s_waitcnt lgkmcnt(0)
    v_xor_b32 v12, 0, v6
    ds_read_b128 v[64:67], v12
    v_xor_b32 v12, 16, v6
    ds_read_b128 v[68:71], v12
    v_xor_b32 v12, 32, v6
    ds_read_b128 v[72:75], v12
    v_xor_b32 v12, 48, v6
    ds_read_b128 v[76:79], v12
    v_xor_b32 v12, 64, v6
    ds_read_b128 v[80:83], v12
    v_xor_b32 v12, 80, v6
    ds_read_b128 v[84:87], v12
    v_xor_b32 v12, 96, v6
    ds_read_b128 v[88:91], v12
    v_xor_b32 v12, 112, v6
    ds_read_b128 v[92:95], v12
    v_xor_b32 v12, 128, v6
    ds_read_b128 v[96:99], v12
    v_xor_b32 v12, 144, v6
    ds_read_b128 v[100:103], v12
    v_xor_b32 v12, 160, v6
    ds_read_b128 v[104:107], v12
    v_xor_b32 v12, 176, v6
    ds_read_b128 v[108:111], v12
    v_xor_b32 v12, 192, v6
    ds_read_b128 v[112:115], v12
    v_xor_b32 v12, 208, v6
    ds_read_b128 v[116:119], v12
    v_xor_b32 v12, 224, v6
    ds_read_b128 v[120:123], v12
    v_xor_b32 v12, 240, v6
    ds_read_b128 v[124:127], v12
    s_waitcnt vmcnt(4)
    buffer_load_dwordx4 v[148:151], v10, s[48:51], s14 offen nt
    s_add_u32 s14, s14, s61
    v_xor_b32 v12, 0, v9
    ds_write_b128 v12, v[128:131] offset:0
    s_waitcnt vmcnt(4)
    buffer_load_dwordx4 v[152:155], v10, s[48:51], s14 offen nt
    s_add_u32 s14, s14, s61
    v_xor_b32 v12, 64, v9
    ds_write_b128 v12, v[132:135] offset:1024
    s_waitcnt vmcnt(4)
    buffer_load_dwordx4 v[156:159], v10, s[48:51], s14 offen nt
    s_add_u32 s14, s14, s61
    v_xor_b32 v12, 160, v9
    ds_write_b128 v12, v[136:139] offset:2048
    s_waitcnt vmcnt(4)
    buffer_load_dwordx4 v[160:163], v10, s[48:51], s14 offen nt
    s_add_u32 s14, s14, s61
    v_xor_b32 v12, 224, v9
    ds_write_b128 v12, v[140:143] offset:3072
    s_waitcnt vmcnt(4)
    buffer_load_dwordx4 v[164:167], v10, s[48:51], s14 offen nt
    s_add_u32 s14, s14, s61
    v_xor_b32 v12, 16, v9
    ds_write_b128 v12, v[144:147] offset:4096
    s_waitcnt vmcnt(4)
    buffer_load_dwordx4 v[168:171], v10, s[48:51], s14 offen nt
    s_add_u32 s14, s14, s61
    v_xor_b32 v12, 80, v9
    ds_write_b128 v12, v[148:151] offset:5120
    s_waitcnt vmcnt(4)
    buffer_load_dwordx4 v[172:175], v10, s[48:51], s14 offen nt
    s_add_u32 s14, s14, s61
    v_xor_b32 v12, 176, v9
    ds_write_b128 v12, v[152:155] offset:6144
    s_waitcnt vmcnt(4)
    buffer_load_dwordx4 v[176:179], v10, s[48:51], s14 offen nt
    s_add_u32 s14, s14, s61
    v_xor_b32 v12, 240, v9
    ds_write_b128 v12, v[156:159] offset:7168
    s_waitcnt vmcnt(4)
    buffer_load_dwordx4 v[180:183], v10, s[48:51], s14 offen nt
    s_add_u32 s14, s14, s61
    v_xor_b32 v12, 32, v9
    ds_write_b128 v12, v[160:163] offset:8192
    s_waitcnt vmcnt(4)
    buffer_load_dwordx4 v[184:187], v10, s[48:51], s14 offen nt
    s_add_u32 s14, s14, s61
    v_xor_b32 v12, 96, v9
    ds_write_b128 v12, v[164:167] offset:9216
    s_waitcnt vmcnt(4)
    buffer_load_dwordx4 v[188:191], v10, s[48:51], s14 offen nt
    v_xor_b32 v12, 128, v9
    ds_write_b128 v12, v[168:171] offset:10240
    s_waitcnt vmcnt(4)
    s_add_u32 s12, s15, 0
    buffer_load_dwordx4 v[192:195], v10, s[44:47], s12 offen offset:0 sc1
    v_xor_b32 v12, 192, v9
    ds_write_b128 v12, v[172:175] offset:11264
    s_waitcnt vmcnt(4)
    buffer_load_dwordx4 v[196:199], v10, s[44:47], s12 offen offset:1024 sc1
    v_xor_b32 v12, 48, v9
    ds_write_b128 v12, v[176:179] offset:12288
    s_waitcnt vmcnt(4)
    buffer_load_dwordx4 v[200:203], v10, s[44:47], s12 offen offset:2048 sc1
    v_xor_b32 v12, 112, v9
    ds_write_b128 v12, v[180:183] offset:13312
    s_waitcnt vmcnt(4)
    buffer_load_dwordx4 v[204:207], v10, s[44:47], s12 offen offset:3072 sc1
    v_xor_b32 v12, 144, v9
    ds_write_b128 v12, v[184:187] offset:14336
    s_waitcnt vmcnt(4)
    s_add_u32 s12, s15, 4096
    buffer_load_dwordx4 v[208:211], v10, s[44:47], s12 offen offset:0 sc1
    v_xor_b32 v12, 208, v9
    ds_write_b128 v12, v[188:191] offset:15360
    s_waitcnt vmcnt(4)
    buffer_load_dwordx4 v[212:215], v10, s[44:47], s12 offen offset:1024 sc1
    s_waitcnt vmcnt(4)
    buffer_load_dwordx4 v[216:219], v10, s[44:47], s12 offen offset:2048 sc1
    s_waitcnt vmcnt(4)
    buffer_load_dwordx4 v[220:223], v10, s[44:47], s12 offen offset:3072 sc1
    s_waitcnt vmcnt(0)
    v_xor_b32 v60, s11, v193
    v_bitop3_b32 v60, v195, s11, v60 bitop3:0xbe
    v_bitop3_b32 v60, v197, s11, v60 bitop3:0xbe
    v_bitop3_b32 v60, v199, s11, v60 bitop3:0xbe
    v_bitop3_b32 v60, v201, s11, v60 bitop3:0xbe
    v_bitop3_b32 v60, v203, s11, v60 bitop3:0xbe
    v_bitop3_b32 v60, v205, s11, v60 bitop3:0xbe
    v_bitop3_b32 v60, v207, s11, v60 bitop3:0xbe
    v_bitop3_b32 v60, v209, s11, v60 bitop3:0xbe
    v_bitop3_b32 v60, v211, s11, v60 bitop3:0xbe
    v_bitop3_b32 v60, v213, s11, v60 bitop3:0xbe
    v_bitop3_b32 v60, v215, s11, v60 bitop3:0xbe
    v_bitop3_b32 v60, v217, s11, v60 bitop3:0xbe
    v_bitop3_b32 v60, v219, s11, v60 bitop3:0xbe
    v_bitop3_b32 v60, v221, s11, v60 bitop3:0xbe
    v_bitop3_b32 v60, v223, s11, v60 bitop3:0xbe
    v_cmp_ne_u32 vcc, 0, v60
    s_cbranch_vccnz L_aqr_19
L_aqb_20:
    v_mov_b32 v193, v194
    v_xor_b32 v12, 0, v4
    ds_write_b64 v12, v[192:193] offset:0
    v_mov_b32 v197, v198
    ds_write_b64 v12, v[196:197] offset:512
    v_mov_b32 v201, v202
    v_xor_b32 v12, 64, v4
    ds_write_b64 v12, v[200:201] offset:1024
    v_mov_b32 v205, v206
    ds_write_b64 v12, v[204:205] offset:1536
    v_mov_b32 v209, v210
    v_xor_b32 v12, 160, v4
    ds_write_b64 v12, v[208:209] offset:2048
    v_mov_b32 v213, v214
    ds_write_b64 v12, v[212:213] offset:2560
    v_mov_b32 v217, v218
    v_xor_b32 v12, 224, v4
    ds_write_b64 v12, v[216:217] offset:3072
    v_mov_b32 v221, v222
    ds_write_b64 v12, v[220:221] offset:3584
    s_waitcnt lgkmcnt(0)
L_acomp:
    s_barrier
    v_xor_b32 v12, 0, v6
    v_xor_b32 v13, 0, v7
    ds_read_b128 v[224:227], v13
    ds_read_b128 v[228:231], v13 offset:16384
    ds_read_b128 v[232:235], v12
    v_xor_b32 v12, 16, v6
    v_xor_b32 v13, 16, v7
    ds_read_b128 v[236:239], v13
    ds_read_b128 v[240:243], v13 offset:16384
    ds_read_b128 v[244:247], v12
    s_waitcnt lgkmcnt(3)
    v_mfma_f32_16x16x32_bf16 v[24:27], v[64:67], v[224:227], 0
    v_mfma_f32_16x16x32_bf16 v[28:31], v[64:67], v[228:231], 0
    v_xor_b32 v12, 32, v6
    v_xor_b32 v13, 32, v7
    ds_read_b128 v[44:47], v13
    ds_read_b128 v[48:51], v13 offset:16384
    ds_read_b128 v[52:55], v12
    buffer_load_dwordx4 v[160:163], v248, s[52:55], s68 offen nt
    s_addk_i32 s68, 0x2000
    v_mfma_f32_16x16x32_bf16 v[16:19], v[232:235], v[224:227], 0
    v_mfma_f32_16x16x32_bf16 v[20:23], v[232:235], v[228:231], 0
    s_waitcnt lgkmcnt(3)
    v_mfma_f32_16x16x32_bf16 v[24:27], v[68:71], v[236:239], v[24:27]
    v_mfma_f32_16x16x32_bf16 v[28:31], v[68:71], v[240:243], v[28:31]
    v_xor_b32 v12, 48, v6
    v_xor_b32 v13, 48, v7
    ds_read_b128 v[224:227], v13
    ds_read_b128 v[228:231], v13 offset:16384
    ds_read_b128 v[232:235], v12
    v_mfma_f32_16x16x32_bf16 v[16:19], v[244:247], v[236:239], v[16:19]
    v_mfma_f32_16x16x32_bf16 v[20:23], v[244:247], v[240:243], v[20:23]
    s_waitcnt lgkmcnt(3)
    v_mfma_f32_16x16x32_bf16 v[24:27], v[72:75], v[44:47], v[24:27]
    v_mfma_f32_16x16x32_bf16 v[28:31], v[72:75], v[48:51], v[28:31]
    v_xor_b32 v12, 64, v6
    v_xor_b32 v13, 64, v7
    ds_read_b128 v[236:239], v13
    ds_read_b128 v[240:243], v13 offset:16384
    ds_read_b128 v[244:247], v12
    v_mfma_f32_16x16x32_bf16 v[16:19], v[52:55], v[44:47], v[16:19]
    v_mfma_f32_16x16x32_bf16 v[20:23], v[52:55], v[48:51], v[20:23]
    s_waitcnt lgkmcnt(3)
    v_mfma_f32_16x16x32_bf16 v[24:27], v[76:79], v[224:227], v[24:27]
    v_mfma_f32_16x16x32_bf16 v[28:31], v[76:79], v[228:231], v[28:31]
    v_xor_b32 v12, 80, v6
    v_xor_b32 v13, 80, v7
    ds_read_b128 v[44:47], v13
    ds_read_b128 v[48:51], v13 offset:16384
    ds_read_b128 v[52:55], v12
    v_mfma_f32_16x16x32_bf16 v[16:19], v[232:235], v[224:227], v[16:19]
    v_mfma_f32_16x16x32_bf16 v[20:23], v[232:235], v[228:231], v[20:23]
    s_waitcnt lgkmcnt(3)
    v_mfma_f32_16x16x32_bf16 v[24:27], v[80:83], v[236:239], v[24:27]
    v_mfma_f32_16x16x32_bf16 v[28:31], v[80:83], v[240:243], v[28:31]
    v_xor_b32 v12, 96, v6
    v_xor_b32 v13, 96, v7
    ds_read_b128 v[224:227], v13
    ds_read_b128 v[228:231], v13 offset:16384
    ds_read_b128 v[232:235], v12
    buffer_load_dwordx4 v[164:167], v248, s[52:55], s68 offen nt
    s_addk_i32 s68, 0x2000
    v_mfma_f32_16x16x32_bf16 v[16:19], v[244:247], v[236:239], v[16:19]
    v_mfma_f32_16x16x32_bf16 v[20:23], v[244:247], v[240:243], v[20:23]
    s_waitcnt lgkmcnt(3)
    v_mfma_f32_16x16x32_bf16 v[24:27], v[84:87], v[44:47], v[24:27]
    v_mfma_f32_16x16x32_bf16 v[28:31], v[84:87], v[48:51], v[28:31]
    v_xor_b32 v12, 112, v6
    v_xor_b32 v13, 112, v7
    ds_read_b128 v[236:239], v13
    ds_read_b128 v[240:243], v13 offset:16384
    ds_read_b128 v[244:247], v12
    v_mfma_f32_16x16x32_bf16 v[16:19], v[52:55], v[44:47], v[16:19]
    v_mfma_f32_16x16x32_bf16 v[20:23], v[52:55], v[48:51], v[20:23]
    s_waitcnt lgkmcnt(3)
    v_mfma_f32_16x16x32_bf16 v[24:27], v[88:91], v[224:227], v[24:27]
    v_mfma_f32_16x16x32_bf16 v[28:31], v[88:91], v[228:231], v[28:31]
    v_xor_b32 v12, 128, v6
    v_xor_b32 v13, 128, v7
    ds_read_b128 v[44:47], v13
    ds_read_b128 v[48:51], v13 offset:16384
    ds_read_b128 v[52:55], v12
    v_mfma_f32_16x16x32_bf16 v[16:19], v[232:235], v[224:227], v[16:19]
    v_mfma_f32_16x16x32_bf16 v[20:23], v[232:235], v[228:231], v[20:23]
    s_waitcnt lgkmcnt(3)
    v_mfma_f32_16x16x32_bf16 v[24:27], v[92:95], v[236:239], v[24:27]
    v_mfma_f32_16x16x32_bf16 v[28:31], v[92:95], v[240:243], v[28:31]
    v_xor_b32 v12, 144, v6
    v_xor_b32 v13, 144, v7
    ds_read_b128 v[224:227], v13
    ds_read_b128 v[228:231], v13 offset:16384
    ds_read_b128 v[232:235], v12
    v_mfma_f32_16x16x32_bf16 v[16:19], v[244:247], v[236:239], v[16:19]
    v_mfma_f32_16x16x32_bf16 v[20:23], v[244:247], v[240:243], v[20:23]
    s_waitcnt lgkmcnt(3)
    v_mfma_f32_16x16x32_bf16 v[24:27], v[96:99], v[44:47], v[24:27]
    v_mfma_f32_16x16x32_bf16 v[28:31], v[96:99], v[48:51], v[28:31]
    v_xor_b32 v12, 160, v6
    v_xor_b32 v13, 160, v7
    ds_read_b128 v[236:239], v13
    ds_read_b128 v[240:243], v13 offset:16384
    ds_read_b128 v[244:247], v12
    buffer_load_dwordx4 v[168:171], v248, s[52:55], s68 offen nt
    s_addk_i32 s68, 0x2000
    v_mfma_f32_16x16x32_bf16 v[16:19], v[52:55], v[44:47], v[16:19]
    v_mfma_f32_16x16x32_bf16 v[20:23], v[52:55], v[48:51], v[20:23]
    s_waitcnt lgkmcnt(3)
    v_mfma_f32_16x16x32_bf16 v[24:27], v[100:103], v[224:227], v[24:27]
    v_mfma_f32_16x16x32_bf16 v[28:31], v[100:103], v[228:231], v[28:31]
    v_xor_b32 v12, 176, v6
    v_xor_b32 v13, 176, v7
    ds_read_b128 v[44:47], v13
    ds_read_b128 v[48:51], v13 offset:16384
    ds_read_b128 v[52:55], v12
    v_mfma_f32_16x16x32_bf16 v[16:19], v[232:235], v[224:227], v[16:19]
    v_mfma_f32_16x16x32_bf16 v[20:23], v[232:235], v[228:231], v[20:23]
    s_waitcnt lgkmcnt(3)
    v_mfma_f32_16x16x32_bf16 v[24:27], v[104:107], v[236:239], v[24:27]
    v_mfma_f32_16x16x32_bf16 v[28:31], v[104:107], v[240:243], v[28:31]
    v_xor_b32 v12, 192, v6
    v_xor_b32 v13, 192, v7
    ds_read_b128 v[224:227], v13
    ds_read_b128 v[228:231], v13 offset:16384
    ds_read_b128 v[232:235], v12
    v_mfma_f32_16x16x32_bf16 v[16:19], v[244:247], v[236:239], v[16:19]
    v_mfma_f32_16x16x32_bf16 v[20:23], v[244:247], v[240:243], v[20:23]
    s_waitcnt lgkmcnt(3)
    v_mfma_f32_16x16x32_bf16 v[24:27], v[108:111], v[44:47], v[24:27]
    v_mfma_f32_16x16x32_bf16 v[28:31], v[108:111], v[48:51], v[28:31]
    v_xor_b32 v12, 208, v6
    v_xor_b32 v13, 208, v7
    ds_read_b128 v[236:239], v13
    ds_read_b128 v[240:243], v13 offset:16384
    ds_read_b128 v[244:247], v12
    v_mfma_f32_16x16x32_bf16 v[16:19], v[52:55], v[44:47], v[16:19]
    v_mfma_f32_16x16x32_bf16 v[20:23], v[52:55], v[48:51], v[20:23]
    s_waitcnt lgkmcnt(3)
    v_mfma_f32_16x16x32_bf16 v[24:27], v[112:115], v[224:227], v[24:27]
    v_mfma_f32_16x16x32_bf16 v[28:31], v[112:115], v[228:231], v[28:31]
    v_xor_b32 v12, 224, v6
    v_xor_b32 v13, 224, v7
    ds_read_b128 v[44:47], v13
    ds_read_b128 v[48:51], v13 offset:16384
    ds_read_b128 v[52:55], v12
    buffer_load_dwordx4 v[172:175], v248, s[52:55], s68 offen nt
    s_addk_i32 s68, 0x2000
    v_mfma_f32_16x16x32_bf16 v[16:19], v[232:235], v[224:227], v[16:19]
    v_mfma_f32_16x16x32_bf16 v[20:23], v[232:235], v[228:231], v[20:23]
    s_waitcnt lgkmcnt(3)
    v_mfma_f32_16x16x32_bf16 v[24:27], v[116:119], v[236:239], v[24:27]
    v_mfma_f32_16x16x32_bf16 v[28:31], v[116:119], v[240:243], v[28:31]
    v_xor_b32 v12, 240, v6
    v_xor_b32 v13, 240, v7
    ds_read_b128 v[224:227], v13
    ds_read_b128 v[228:231], v13 offset:16384
    ds_read_b128 v[232:235], v12
    v_mfma_f32_16x16x32_bf16 v[16:19], v[244:247], v[236:239], v[16:19]
    v_mfma_f32_16x16x32_bf16 v[20:23], v[244:247], v[240:243], v[20:23]
    s_waitcnt lgkmcnt(3)
    v_mfma_f32_16x16x32_bf16 v[24:27], v[120:123], v[44:47], v[24:27]
    v_mfma_f32_16x16x32_bf16 v[28:31], v[120:123], v[48:51], v[28:31]
    v_mfma_f32_16x16x32_bf16 v[16:19], v[52:55], v[44:47], v[16:19]
    v_mfma_f32_16x16x32_bf16 v[20:23], v[52:55], v[48:51], v[20:23]
    s_waitcnt lgkmcnt(0)
    v_mfma_f32_16x16x32_bf16 v[24:27], v[124:127], v[224:227], v[24:27]
    v_mfma_f32_16x16x32_bf16 v[28:31], v[124:127], v[228:231], v[28:31]
    v_mfma_f32_16x16x32_bf16 v[16:19], v[232:235], v[224:227], v[16:19]
    v_mfma_f32_16x16x32_bf16 v[20:23], v[232:235], v[228:231], v[20:23]
    s_nop 6
    v_max3_f32 v56, v16, v17, v18
    v_max3_f32 v56, v56, v19, v24
    v_max3_f32 v56, v56, v25, v26
    v_max_f32 v56, v56, v27
    v_max3_f32 v57, v20, v21, v22
    v_max3_f32 v57, v57, v23, v28
    v_max3_f32 v57, v57, v29, v30
    v_max_f32 v57, v57, v31
    v_mov_b32 v58, v56
    v_mov_b32 v59, v57
    s_nop 0
    v_permlane32_swap_b32 v58, v56
    v_permlane32_swap_b32 v59, v57
    v_max_f32 v56, v58, v56
    v_max_f32 v57, v59, v57
    v_mov_b32 v58, v56
    v_mov_b32 v59, v57
    s_nop 0
    v_permlane16_swap_b32 v58, v56
    v_permlane16_swap_b32 v59, v57
    v_max_f32 v56, v58, v56
    v_max_f32 v57, v59, v57
    s_barrier
    s_mov_b32 exec_lo, 0xffff
    s_mov_b32 exec_hi, 0x0
    ds_write_b32 v251, v56
    ds_write_b32 v251, v57 offset:512
    s_mov_b64 exec, -1
    s_waitcnt lgkmcnt(0)
    s_barrier
    ds_read_b128 v[224:227], v250 offset:0
    ds_read_b128 v[228:231], v250 offset:16
    ds_read_b128 v[232:235], v250 offset:512
    ds_read_b128 v[236:239], v250 offset:528
    s_waitcnt lgkmcnt(0)
    v_max3_f32 v56, v224, v225, v226
    v_max3_f32 v56, v56, v227, v228
    v_max3_f32 v56, v56, v229, v230
    v_max_f32 v56, v56, v231
    v_mul_f32 v56, s60, v56
    v_max3_f32 v57, v232, v233, v234
    v_max3_f32 v57, v57, v235, v236
    v_max3_f32 v57, v57, v237, v238
    v_max_f32 v57, v57, v239
    v_mul_f32 v57, s60, v57
    v_fma_f32 v16, v16, s60, -v56
    v_fma_f32 v17, v17, s60, -v56
    v_fma_f32 v18, v18, s60, -v56
    v_fma_f32 v19, v19, s60, -v56
    v_fma_f32 v20, v20, s60, -v57
    v_fma_f32 v21, v21, s60, -v57
    v_fma_f32 v22, v22, s60, -v57
    v_fma_f32 v23, v23, s60, -v57
    v_fma_f32 v24, v24, s60, -v56
    v_fma_f32 v25, v25, s60, -v56
    v_fma_f32 v26, v26, s60, -v56
    v_fma_f32 v27, v27, s60, -v56
    v_fma_f32 v28, v28, s60, -v57
    v_fma_f32 v29, v29, s60, -v57
    v_fma_f32 v30, v30, s60, -v57
    v_fma_f32 v31, v31, s60, -v57
    buffer_load_dwordx4 v[176:179], v248, s[52:55], s68 offen nt
    s_addk_i32 s68, 0x2000
    v_exp_f32 v16, v16
    v_exp_f32 v17, v17
    v_exp_f32 v18, v18
    v_exp_f32 v19, v19
    v_exp_f32 v20, v20
    v_exp_f32 v21, v21
    v_exp_f32 v22, v22
    v_exp_f32 v23, v23
    v_exp_f32 v24, v24
    v_exp_f32 v25, v25
    v_exp_f32 v26, v26
    v_exp_f32 v27, v27
    v_exp_f32 v28, v28
    v_exp_f32 v29, v29
    v_exp_f32 v30, v30
    v_exp_f32 v31, v31
    v_cvt_pk_bf16_f32 v56, v16, v17
    v_cvt_pk_bf16_f32 v57, v18, v19
    ds_write_b64 v252, v[56:57] offset:0
    v_cvt_pk_bf16_f32 v58, v20, v21
    v_cvt_pk_bf16_f32 v59, v22, v23
    ds_write_b64 v252, v[58:59] offset:8192
    v_cvt_pk_bf16_f32 v60, v24, v25
    v_cvt_pk_bf16_f32 v61, v26, v27
    ds_write_b64 v252, v[60:61] offset:256
    v_cvt_pk_bf16_f32 v62, v28, v29
    v_cvt_pk_bf16_f32 v63, v30, v31
    ds_write_b64 v252, v[62:63] offset:8448
    v_add_u32 v4, 0x10000, v32
    v_add_u32 v5, 0x10000, v33
    v_add_u32 v11, 0x10000, v34
    v_add_u32 v13, 0x10000, v35
    ds_read_b64_tr_b16 v[228:229], v32 offset:0
    ds_read_b64_tr_b16 v[230:231], v33 offset:0
    ds_read_b64_tr_b16 v[232:233], v34 offset:0
    ds_read_b64_tr_b16 v[234:235], v35 offset:0
    ds_read_b64_tr_b16 v[240:241], v32 offset:16384
    ds_read_b64_tr_b16 v[242:243], v33 offset:16384
    ds_read_b64_tr_b16 v[244:245], v34 offset:16384
    ds_read_b64_tr_b16 v[246:247], v35 offset:16384
    s_waitcnt lgkmcnt(8)
    s_barrier
    v_xor_b32 v12, 0, v253
    ds_read_b128 v[224:227], v12 offset:0
    v_xor_b32 v12, 32, v253
    ds_read_b128 v[236:239], v12 offset:0
    s_waitcnt lgkmcnt(1)
    v_mfma_f32_32x32x16_bf16 v[128:143], v[228:231], v[224:227], 0
    v_xor_b32 v12, 64, v253
    ds_read_b128 v[44:47], v12 offset:0
    ds_read_b64_tr_b16 v[48:49], v32 offset:32768
    ds_read_b64_tr_b16 v[50:51], v33 offset:32768
    ds_read_b64_tr_b16 v[52:53], v34 offset:32768
    ds_read_b64_tr_b16 v[54:55], v35 offset:32768
    v_add_f32 v16, v16, v17
    v_add_f32 v16, v16, v18
    v_add_f32 v16, v16, v19
    v_add_f32 v16, v16, v24
    v_mfma_f32_32x32x16_bf16 v[144:159], v[232:235], v[224:227], 0
    v_add_f32 v16, v16, v25
    v_add_f32 v16, v16, v26
    v_add_f32 v16, v16, v27
    v_add_f32 v20, v20, v21
    s_waitcnt lgkmcnt(5)
    v_mfma_f32_32x32x16_bf16 v[128:143], v[240:243], v[236:239], v[128:143]
    v_xor_b32 v12, 96, v253
    ds_read_b128 v[224:227], v12 offset:0
    ds_read_b64_tr_b16 v[228:229], v32 offset:49152
    ds_read_b64_tr_b16 v[230:231], v33 offset:49152
    ds_read_b64_tr_b16 v[232:233], v34 offset:49152
    ds_read_b64_tr_b16 v[234:235], v35 offset:49152
    v_add_f32 v20, v20, v22
    v_add_f32 v20, v20, v23
    v_add_f32 v20, v20, v28
    v_add_f32 v20, v20, v29
    v_mfma_f32_32x32x16_bf16 v[144:159], v[244:247], v[236:239], v[144:159]
    v_add_f32 v20, v20, v30
    v_add_f32 v20, v20, v31
    v_mov_b32 v17, v16
    v_mov_b32 v21, v20
    s_waitcnt lgkmcnt(5)
    v_mfma_f32_32x32x16_bf16 v[128:143], v[48:51], v[44:47], v[128:143]
    v_xor_b32 v12, 128, v253
    ds_read_b128 v[236:239], v12 offset:0
    ds_read_b64_tr_b16 v[240:241], v4 offset:0
    ds_read_b64_tr_b16 v[242:243], v5 offset:0
    ds_read_b64_tr_b16 v[244:245], v11 offset:0
    ds_read_b64_tr_b16 v[246:247], v13 offset:0
    v_permlane32_swap_b32 v17, v16
    v_permlane32_swap_b32 v21, v20
    v_add_f32 v16, v17, v16
    v_add_f32 v20, v21, v20
    v_mfma_f32_32x32x16_bf16 v[144:159], v[52:55], v[44:47], v[144:159]
    v_mov_b32 v17, v16
    v_mov_b32 v21, v20
    s_nop 0
    v_permlane16_swap_b32 v17, v16
    v_permlane16_swap_b32 v21, v20
    s_waitcnt lgkmcnt(5)
    v_mfma_f32_32x32x16_bf16 v[128:143], v[228:231], v[224:227], v[128:143]
    v_xor_b32 v12, 160, v253
    ds_read_b128 v[44:47], v12 offset:0
    ds_read_b64_tr_b16 v[48:49], v4 offset:16384
    ds_read_b64_tr_b16 v[50:51], v5 offset:16384
    ds_read_b64_tr_b16 v[52:53], v11 offset:16384
    ds_read_b64_tr_b16 v[54:55], v13 offset:16384
    v_add_f32 v16, v17, v16
    v_add_f32 v20, v21, v20
    v_mfma_f32_32x32x16_bf16 v[144:159], v[232:235], v[224:227], v[144:159]
    s_mov_b32 exec_lo, 0xffff
    s_mov_b32 exec_hi, 0x0
    ds_write_b32 v251, v16 offset:1024
    ds_write_b32 v251, v20 offset:1536
    s_mov_b64 exec, -1
    buffer_load_dwordx4 v[180:183], v248, s[52:55], s68 offen nt
    s_addk_i32 s68, 0x2000
    s_barrier
    s_cmp_lt_u32 s6, 4
    s_cbranch_scc1 L_pvw_21
    s_waitcnt lgkmcnt(7)
    v_mfma_f32_32x32x16_bf16 v[128:143], v[240:243], v[236:239], v[128:143]
    v_xor_b32 v12, 192, v253
    ds_read_b128 v[224:227], v12 offset:0
    ds_read_b64_tr_b16 v[228:229], v4 offset:32768
    ds_read_b64_tr_b16 v[230:231], v5 offset:32768
    ds_read_b64_tr_b16 v[232:233], v11 offset:32768
    ds_read_b64_tr_b16 v[234:235], v13 offset:32768
    v_mfma_f32_32x32x16_bf16 v[144:159], v[244:247], v[236:239], v[144:159]
    s_waitcnt lgkmcnt(7)
    v_mfma_f32_32x32x16_bf16 v[128:143], v[48:51], v[44:47], v[128:143]
    v_xor_b32 v12, 224, v253
    ds_read_b128 v[236:239], v12 offset:0
    ds_read_b64_tr_b16 v[240:241], v4 offset:49152
    ds_read_b64_tr_b16 v[242:243], v5 offset:49152
    ds_read_b64_tr_b16 v[244:245], v11 offset:49152
    ds_read_b64_tr_b16 v[246:247], v13 offset:49152
    buffer_load_dwordx4 v[184:187], v248, s[52:55], s68 offen nt
    s_addk_i32 s68, 0x2000
    v_mfma_f32_32x32x16_bf16 v[144:159], v[52:55], v[44:47], v[144:159]
    s_waitcnt lgkmcnt(5)
    v_mfma_f32_32x32x16_bf16 v[128:143], v[228:231], v[224:227], v[128:143]
    v_mfma_f32_32x32x16_bf16 v[144:159], v[232:235], v[224:227], v[144:159]
    s_waitcnt lgkmcnt(0)
    v_mfma_f32_32x32x16_bf16 v[128:143], v[240:243], v[236:239], v[128:143]
    v_mfma_f32_32x32x16_bf16 v[144:159], v[244:247], v[236:239], v[144:159]
    s_branch L_pvj_22
L_pvw_21:
    s_waitcnt lgkmcnt(7)
    v_mfma_f32_32x32x16_bf16 v[128:143], v[240:243], v[236:239], v[128:143]
    v_xor_b32 v12, 192, v253
    ds_read_b128 v[224:227], v12 offset:0
    ds_read_b64_tr_b16 v[228:229], v4 offset:32768
    ds_read_b64_tr_b16 v[230:231], v5 offset:32768
    ds_read_b64_tr_b16 v[232:233], v11 offset:32768
    ds_read_b64_tr_b16 v[234:235], v13 offset:32768
    v_mfma_f32_32x32x16_bf16 v[144:159], v[244:247], v[236:239], v[144:159]
    v_xor_b32 v12, 0, v6
    ds_write_b128 v12, v[64:67]
    v_xor_b32 v12, 16, v6
    ds_write_b128 v12, v[68:71]
    v_xor_b32 v12, 32, v6
    ds_write_b128 v12, v[72:75]
    v_xor_b32 v12, 48, v6
    ds_write_b128 v12, v[76:79]
    s_waitcnt lgkmcnt(11)
    v_mfma_f32_32x32x16_bf16 v[128:143], v[48:51], v[44:47], v[128:143]
    v_xor_b32 v12, 224, v253
    ds_read_b128 v[236:239], v12 offset:0
    ds_read_b64_tr_b16 v[240:241], v4 offset:49152
    ds_read_b64_tr_b16 v[242:243], v5 offset:49152
    ds_read_b64_tr_b16 v[244:245], v11 offset:49152
    ds_read_b64_tr_b16 v[246:247], v13 offset:49152
    buffer_load_dwordx4 v[184:187], v248, s[52:55], s68 offen nt
    s_addk_i32 s68, 0x2000
    v_mfma_f32_32x32x16_bf16 v[144:159], v[52:55], v[44:47], v[144:159]
    v_xor_b32 v12, 64, v6
    ds_write_b128 v12, v[80:83]
    v_xor_b32 v12, 80, v6
    ds_write_b128 v12, v[84:87]
    v_xor_b32 v12, 96, v6
    ds_write_b128 v12, v[88:91]
    v_xor_b32 v12, 112, v6
    ds_write_b128 v12, v[92:95]
    s_waitcnt lgkmcnt(13)
    v_mfma_f32_32x32x16_bf16 v[128:143], v[228:231], v[224:227], v[128:143]
    v_mfma_f32_32x32x16_bf16 v[144:159], v[232:235], v[224:227], v[144:159]
    v_xor_b32 v12, 128, v6
    ds_write_b128 v12, v[96:99]
    v_xor_b32 v12, 144, v6
    ds_write_b128 v12, v[100:103]
    v_xor_b32 v12, 160, v6
    ds_write_b128 v12, v[104:107]
    v_xor_b32 v12, 176, v6
    ds_write_b128 v12, v[108:111]
    s_waitcnt lgkmcnt(8)
    v_mfma_f32_32x32x16_bf16 v[128:143], v[240:243], v[236:239], v[128:143]
    v_mfma_f32_32x32x16_bf16 v[144:159], v[244:247], v[236:239], v[144:159]
    v_xor_b32 v12, 192, v6
    ds_write_b128 v12, v[112:115]
    v_xor_b32 v12, 208, v6
    ds_write_b128 v12, v[116:119]
    v_xor_b32 v12, 224, v6
    ds_write_b128 v12, v[120:123]
    v_xor_b32 v12, 240, v6
    ds_write_b128 v12, v[124:127]
    s_waitcnt lgkmcnt(0)
L_pvj_22:
    buffer_load_dwordx4 v[188:191], v248, s[52:55], s68 offen nt
    s_barrier
    s_cmp_lt_u32 s6, 4
    s_cbranch_scc0 L_pvw_23
    v_xor_b32 v12, 0, v253
    ds_read_b128 v[224:227], v12 offset:256
    ds_read_b64_tr_b16 v[228:229], v32 offset:0
    ds_read_b64_tr_b16 v[230:231], v33 offset:0
    ds_read_b64_tr_b16 v[232:233], v34 offset:0
    ds_read_b64_tr_b16 v[234:235], v35 offset:0
    v_xor_b32 v12, 32, v253
    ds_read_b128 v[236:239], v12 offset:256
    ds_read_b64_tr_b16 v[240:241], v32 offset:16384
    ds_read_b64_tr_b16 v[242:243], v33 offset:16384
    ds_read_b64_tr_b16 v[244:245], v34 offset:16384
    ds_read_b64_tr_b16 v[246:247], v35 offset:16384
    s_waitcnt lgkmcnt(5)
    v_mfma_f32_32x32x16_bf16 v[128:143], v[228:231], v[224:227], v[128:143]
    v_xor_b32 v12, 64, v253
    ds_read_b128 v[44:47], v12 offset:256
    ds_read_b64_tr_b16 v[48:49], v32 offset:32768
    ds_read_b64_tr_b16 v[50:51], v33 offset:32768
    ds_read_b64_tr_b16 v[52:53], v34 offset:32768
    ds_read_b64_tr_b16 v[54:55], v35 offset:32768
    v_mfma_f32_32x32x16_bf16 v[144:159], v[232:235], v[224:227], v[144:159]
    s_waitcnt lgkmcnt(5)
    v_mfma_f32_32x32x16_bf16 v[128:143], v[240:243], v[236:239], v[128:143]
    v_xor_b32 v12, 96, v253
    ds_read_b128 v[224:227], v12 offset:256
    ds_read_b64_tr_b16 v[228:229], v32 offset:49152
    ds_read_b64_tr_b16 v[230:231], v33 offset:49152
    ds_read_b64_tr_b16 v[232:233], v34 offset:49152
    ds_read_b64_tr_b16 v[234:235], v35 offset:49152
    buffer_load_dwordx4 v[192:195], v249, s[56:59], s69 offen offset:0 nt
    v_mfma_f32_32x32x16_bf16 v[144:159], v[244:247], v[236:239], v[144:159]
    s_waitcnt lgkmcnt(5)
    v_mfma_f32_32x32x16_bf16 v[128:143], v[48:51], v[44:47], v[128:143]
    v_mfma_f32_32x32x16_bf16 v[144:159], v[52:55], v[44:47], v[144:159]
    s_waitcnt lgkmcnt(0)
    v_mfma_f32_32x32x16_bf16 v[128:143], v[228:231], v[224:227], v[128:143]
    v_mfma_f32_32x32x16_bf16 v[144:159], v[232:235], v[224:227], v[144:159]
    s_branch L_pvj_24
L_pvw_23:
    v_xor_b32 v12, 0, v253
    ds_read_b128 v[224:227], v12 offset:256
    ds_read_b64_tr_b16 v[228:229], v32 offset:0
    ds_read_b64_tr_b16 v[230:231], v33 offset:0
    ds_read_b64_tr_b16 v[232:233], v34 offset:0
    ds_read_b64_tr_b16 v[234:235], v35 offset:0
    v_xor_b32 v12, 32, v253
    ds_read_b128 v[236:239], v12 offset:256
    ds_read_b64_tr_b16 v[240:241], v32 offset:16384
    ds_read_b64_tr_b16 v[242:243], v33 offset:16384
    ds_read_b64_tr_b16 v[244:245], v34 offset:16384
    ds_read_b64_tr_b16 v[246:247], v35 offset:16384
    s_waitcnt lgkmcnt(5)
    v_mfma_f32_32x32x16_bf16 v[128:143], v[228:231], v[224:227], v[128:143]
    v_xor_b32 v12, 64, v253
    ds_read_b128 v[44:47], v12 offset:256
    ds_read_b64_tr_b16 v[48:49], v32 offset:32768
    ds_read_b64_tr_b16 v[50:51], v33 offset:32768
    ds_read_b64_tr_b16 v[52:53], v34 offset:32768
    ds_read_b64_tr_b16 v[54:55], v35 offset:32768
    v_mfma_f32_32x32x16_bf16 v[144:159], v[232:235], v[224:227], v[144:159]
    v_xor_b32 v12, 0, v6
    ds_write_b128 v12, v[64:67]
    v_xor_b32 v12, 16, v6
    ds_write_b128 v12, v[68:71]
    v_xor_b32 v12, 32, v6
    ds_write_b128 v12, v[72:75]
    v_xor_b32 v12, 48, v6
    ds_write_b128 v12, v[76:79]
    s_waitcnt lgkmcnt(9)
    v_mfma_f32_32x32x16_bf16 v[128:143], v[240:243], v[236:239], v[128:143]
    v_xor_b32 v12, 96, v253
    ds_read_b128 v[224:227], v12 offset:256
    ds_read_b64_tr_b16 v[228:229], v32 offset:49152
    ds_read_b64_tr_b16 v[230:231], v33 offset:49152
    ds_read_b64_tr_b16 v[232:233], v34 offset:49152
    ds_read_b64_tr_b16 v[234:235], v35 offset:49152
    buffer_load_dwordx4 v[192:195], v249, s[56:59], s69 offen offset:0 nt
    v_mfma_f32_32x32x16_bf16 v[144:159], v[244:247], v[236:239], v[144:159]
    v_xor_b32 v12, 64, v6
    ds_write_b128 v12, v[80:83]
    v_xor_b32 v12, 80, v6
    ds_write_b128 v12, v[84:87]
    v_xor_b32 v12, 96, v6
    ds_write_b128 v12, v[88:91]
    v_xor_b32 v12, 112, v6
    ds_write_b128 v12, v[92:95]
    s_waitcnt lgkmcnt(13)
    v_mfma_f32_32x32x16_bf16 v[128:143], v[48:51], v[44:47], v[128:143]
    v_mfma_f32_32x32x16_bf16 v[144:159], v[52:55], v[44:47], v[144:159]
    v_xor_b32 v12, 128, v6
    ds_write_b128 v12, v[96:99]
    v_xor_b32 v12, 144, v6
    ds_write_b128 v12, v[100:103]
    v_xor_b32 v12, 160, v6
    ds_write_b128 v12, v[104:107]
    v_xor_b32 v12, 176, v6
    ds_write_b128 v12, v[108:111]
    s_waitcnt lgkmcnt(8)
    v_mfma_f32_32x32x16_bf16 v[128:143], v[228:231], v[224:227], v[128:143]
    v_mfma_f32_32x32x16_bf16 v[144:159], v[232:235], v[224:227], v[144:159]
    v_xor_b32 v12, 192, v6
    ds_write_b128 v12, v[112:115]
    v_xor_b32 v12, 208, v6
    ds_write_b128 v12, v[116:119]
    v_xor_b32 v12, 224, v6
    ds_write_b128 v12, v[120:123]
    v_xor_b32 v12, 240, v6
    ds_write_b128 v12, v[124:127]
    s_waitcnt lgkmcnt(0)
L_pvj_24:
    buffer_load_dwordx4 v[196:199], v249, s[56:59], s69 offen offset:1024 nt
    s_barrier
    v_xor_b32 v12, 128, v253
    ds_read_b128 v[236:239], v12 offset:256
    ds_read_b64_tr_b16 v[240:241], v4 offset:0
    ds_read_b64_tr_b16 v[242:243], v5 offset:0
    ds_read_b64_tr_b16 v[244:245], v11 offset:0
    ds_read_b64_tr_b16 v[246:247], v13 offset:0
    v_xor_b32 v12, 160, v253
    ds_read_b128 v[44:47], v12 offset:256
    ds_read_b64_tr_b16 v[48:49], v4 offset:16384
    ds_read_b64_tr_b16 v[50:51], v5 offset:16384
    ds_read_b64_tr_b16 v[52:53], v11 offset:16384
    ds_read_b64_tr_b16 v[54:55], v13 offset:16384
    s_waitcnt lgkmcnt(5)
    v_mfma_f32_32x32x16_bf16 v[128:143], v[240:243], v[236:239], v[128:143]
    v_xor_b32 v12, 192, v253
    ds_read_b128 v[224:227], v12 offset:256
    ds_read_b64_tr_b16 v[228:229], v4 offset:32768
    ds_read_b64_tr_b16 v[230:231], v5 offset:32768
    ds_read_b64_tr_b16 v[232:233], v11 offset:32768
    ds_read_b64_tr_b16 v[234:235], v13 offset:32768
    v_and_b32 v24, 3, v8
    v_lshlrev_b32 v21, 5, v24
    s_lshl_b32 s3, s6, 7
    s_add_u32 s3, s3, 147456
    v_add_u32 v21, s3, v21
    v_and_b32 v20, 1, v3
    v_lshlrev_b32 v252, 5, v20
    v_mfma_f32_32x32x16_bf16 v[144:159], v[244:247], v[236:239], v[144:159]
    v_lshl_add_u32 v252, v2, 6, v252
    v_lshl_add_u32 v252, v15, 4, v252
    s_and_b32 s3, s6, 3
    s_lshl_b32 s14, s3, 8
    v_lshrrev_b32 v22, 2, v252
    v_add_u32 v22, s14, v22
    s_lshl_b32 s12, s65, 16
    s_waitcnt lgkmcnt(5)
    v_mfma_f32_32x32x16_bf16 v[128:143], v[48:51], v[44:47], v[128:143]
    v_xor_b32 v12, 224, v253
    ds_read_b128 v[236:239], v12 offset:256
    ds_read_b64_tr_b16 v[240:241], v4 offset:49152
    ds_read_b64_tr_b16 v[242:243], v5 offset:49152
    ds_read_b64_tr_b16 v[244:245], v11 offset:49152
    ds_read_b64_tr_b16 v[246:247], v13 offset:49152
    s_add_u32 s12, s12, s14
    s_add_u32 s12, s12, 2097152
    v_lshlrev_b32 v15, 10, v3
    v_lshl_add_u32 v15, v2, 4, v15
    v_bfe_u32 v16, v1, 3, 1
    v_lshlrev_b32 v17, 7, v16
    v_lshl_add_u32 v17, v3, 5, v17
    v_mfma_f32_32x32x16_bf16 v[144:159], v[52:55], v[44:47], v[144:159]
    v_add_u32 v17, s14, v17
    s_lshl_b32 s3, s6, 10
    v_add_u32 v18, s3, v10
    v_and_b32 v19, 3, v1
    v_lshlrev_b32 v19, 4, v19
    v_lshrrev_b32 v23, 2, v1
    v_add_u32 v19, v19, v23
    s_waitcnt lgkmcnt(5)
    v_mfma_f32_32x32x16_bf16 v[128:143], v[228:231], v[224:227], v[128:143]
    v_lshlrev_b32 v19, 1, v19
    v_add_u32 v19, s14, v19
    v_lshlrev_b32 v20, 4, v16
    v_lshl_add_u32 v20, v3, 5, v20
    s_lshl_b32 s3, s6, 7
    v_add_u32 v20, s3, v20
    v_lshlrev_b32 v23, 8, v16
    v_mfma_f32_32x32x16_bf16 v[144:159], v[232:235], v[224:227], v[144:159]
    v_lshl_add_u32 v23, v8, 4, v23
    v_lshl_add_u32 v23, v3, 11, v23
    v_lshlrev_b32 v250, 3, v16
    v_lshl_add_u32 v250, v8, 4, v250
    v_lshl_add_u32 v250, v3, 1, v250
    v_add_u32 v250, s3, v250
    s_lshr_b32 s14, s6, 2
    s_waitcnt lgkmcnt(0)
    v_mfma_f32_32x32x16_bf16 v[128:143], v[240:243], v[236:239], v[128:143]
    s_lshl_b32 s14, s14, 6
    s_add_u32 s3, s3, s14
    v_lshlrev_b32 v251, 4, v3
    v_add_u32 v251, s3, v251
    v_lshlrev_b32 v14, 4, v1
    s_lshl_b32 s15, s65, 10
    s_add_u32 s15, s15, 720896
    v_mfma_f32_32x32x16_bf16 v[144:159], v[244:247], v[236:239], v[144:159]
    s_mov_b32 s18, 0x11111111
    s_mov_b32 s19, 0x11111111
    s_mov_b32 s13, 0
    s_lshl_b32 s61, s64, 12
    s_lshl_b32 s3, s6, 10
    s_add_u32 s61, s61, s3
    s_add_u32 s61, s61, 1310720
    s_barrier
    s_cmp_lt_u32 s6, 4
    v_cvt_pk_bf16_f32 v128, v128, v129
    v_cvt_pk_bf16_f32 v129, v130, v131
    v_xor_b32 v12, 0, v254
    ds_write_b64 v12, v[128:129]
    v_cvt_pk_bf16_f32 v132, v132, v133
    v_cvt_pk_bf16_f32 v133, v134, v135
    v_xor_b32 v12, 16, v254
    ds_write_b64 v12, v[132:133]
    v_cvt_pk_bf16_f32 v136, v136, v137
    v_cvt_pk_bf16_f32 v137, v138, v139
    v_xor_b32 v12, 32, v254
    ds_write_b64 v12, v[136:137]
    v_cvt_pk_bf16_f32 v140, v140, v141
    v_cvt_pk_bf16_f32 v141, v142, v143
    v_xor_b32 v12, 48, v254
    ds_write_b64 v12, v[140:141]
    v_cvt_pk_bf16_f32 v144, v144, v145
    v_cvt_pk_bf16_f32 v145, v146, v147
    v_xor_b32 v12, 64, v254
    ds_write_b64 v12, v[144:145]
    v_cvt_pk_bf16_f32 v148, v148, v149
    v_cvt_pk_bf16_f32 v149, v150, v151
    v_xor_b32 v12, 80, v254
    ds_write_b64 v12, v[148:149]
    v_cvt_pk_bf16_f32 v152, v152, v153
    v_cvt_pk_bf16_f32 v153, v154, v155
    v_xor_b32 v12, 96, v254
    ds_write_b64 v12, v[152:153]
    v_cvt_pk_bf16_f32 v156, v156, v157
    v_cvt_pk_bf16_f32 v157, v158, v159
    v_xor_b32 v12, 112, v254
    ds_write_b64 v12, v[156:157]
    s_waitcnt lgkmcnt(0)
    s_barrier
    v_mov_b32 v53, s11
    v_mov_b32 v55, s11
    v_xor_b32 v12, 0, v255
    ds_read_b128 v[64:67], v12 offset:0
    v_xor_b32 v12, 16, v255
    ds_read_b128 v[68:71], v12 offset:1024
    v_xor_b32 v12, 32, v255
    ds_read_b128 v[72:75], v12 offset:2048
    v_xor_b32 v12, 48, v255
    ds_read_b128 v[76:79], v12 offset:3072
    ds_read_b128 v[96:99], v21 offset:0
    ds_read_b128 v[100:103], v21 offset:16
    ds_read_b128 v[104:107], v21 offset:1024
    ds_read_b128 v[108:111], v21 offset:1040
    s_waitcnt lgkmcnt(7)
    buffer_store_dwordx4 v[64:67], v10, s[44:47], s16 offen sc1
    s_add_u32 s16, s16, s17
    s_waitcnt lgkmcnt(6)
    buffer_store_dwordx4 v[68:71], v10, s[44:47], s16 offen sc1
    s_add_u32 s16, s16, s17
    s_waitcnt lgkmcnt(5)
    buffer_store_dwordx4 v[72:75], v10, s[44:47], s16 offen sc1
    s_add_u32 s16, s16, s17
    s_waitcnt lgkmcnt(4)
    buffer_store_dwordx4 v[76:79], v10, s[44:47], s16 offen sc1
    s_cmp_lt_u32 s6, 4
    s_cbranch_scc1 L_ast
    buffer_load_dwordx4 v[224:227], v14, s[44:47], s15 offen sc1
L_ast:
    v_lshlrev_b32 v13, 10, v24
    s_lshl_b32 s16, s64, 4
    s_lshl_b32 s3, s6, 12
    s_add_u32 s16, s16, s3
    s_add_u32 s16, s16, 720896
    s_waitcnt lgkmcnt(0)
    v_max3_f32 v52, v96, v97, v98
    v_max3_f32 v52, v52, v99, v100
    v_max3_f32 v52, v52, v101, v102
    v_max_f32 v52, v52, v103
    v_mul_f32 v52, s60, v52
    v_add_f32 v54, v104, v105
    v_add_f32 v54, v54, v106
    v_add_f32 v54, v54, v107
    v_add_f32 v54, v54, v108
    v_add_f32 v54, v54, v109
    v_add_f32 v54, v54, v110
    v_add_f32 v54, v54, v111
    s_mov_b64 exec, 0xf
    s_waitcnt vmcnt(0)
    buffer_store_dwordx4 v[52:55], v13, s[44:47], s16 offen sc1
    s_mov_b64 exec, -1
    s_cmp_lt_u32 s6, 4
    s_cbranch_scc0 L_agl3
    s_barrier
    buffer_load_dwordx4 v[200:203], v249, s[56:59], s69 offen offset:2048 nt
    buffer_load_dwordx4 v[204:207], v249, s[56:59], s69 offen offset:3072 nt
    s_addk_i32 s69, 0x1000
    buffer_load_dwordx4 v[208:211], v249, s[56:59], s69 offen offset:0 nt
    buffer_load_dwordx4 v[212:215], v249, s[56:59], s69 offen offset:1024 nt
    buffer_load_dwordx4 v[216:219], v249, s[56:59], s69 offen offset:2048 nt
    buffer_load_dwordx4 v[220:223], v249, s[56:59], s69 offen offset:3072 nt
    s_branch L_alat
L_agl:
    buffer_load_dwordx4 v[224:227], v14, s[44:47], s15 offen sc1
L_agl2:
    s_add_u32 s13, s13, 1
    s_waitcnt vmcnt(0)
L_agl3:
    v_xor_b32 v60, s11, v225
    v_bitop3_b32 v60, v227, s11, v60 bitop3:0xbe
    v_cmp_eq_u32 vcc, 0, v60
    s_cmp_gt_u32 s13, 400000
    s_cselect_b64 vcc, -1, vcc
    s_lshr_b64 s[4:5], vcc, 1
    s_and_b64 s[4:5], s[4:5], vcc
    s_lshr_b64 s[20:21], s[4:5], 2
    s_and_b64 s[4:5], s[4:5], s[20:21]
    s_and_b64 s[4:5], s[4:5], s[18:19]
    s_andn2_b64 s[18:19], s[18:19], s[4:5]
    s_bitcmp1_b64 s[4:5], 0
    s_cbranch_scc0 L_agi_25
    s_add_u32 s3, s12, 0
    buffer_load_dwordx4 v[64:67], v15, s[44:47], s3 offen sc1
L_agi_25:
    s_bitcmp1_b64 s[4:5], 4
    s_cbranch_scc0 L_agi_26
    s_add_u32 s3, s12, 4096
    buffer_load_dwordx4 v[68:71], v15, s[44:47], s3 offen sc1
L_agi_26:
    s_bitcmp1_b64 s[4:5], 8
    s_cbranch_scc0 L_agi_27
    s_add_u32 s3, s12, 8192
    buffer_load_dwordx4 v[72:75], v15, s[44:47], s3 offen sc1
L_agi_27:
    s_bitcmp1_b64 s[4:5], 12
    s_cbranch_scc0 L_agi_28
    s_add_u32 s3, s12, 12288
    buffer_load_dwordx4 v[76:79], v15, s[44:47], s3 offen sc1
L_agi_28:
    s_bitcmp1_b64 s[4:5], 16
    s_cbranch_scc0 L_agi_29
    s_add_u32 s3, s12, 16384
    buffer_load_dwordx4 v[80:83], v15, s[44:47], s3 offen sc1
L_agi_29:
    s_bitcmp1_b64 s[4:5], 20
    s_cbranch_scc0 L_agi_30
    s_add_u32 s3, s12, 20480
    buffer_load_dwordx4 v[84:87], v15, s[44:47], s3 offen sc1
L_agi_30:
    s_bitcmp1_b64 s[4:5], 24
    s_cbranch_scc0 L_agi_31
    s_add_u32 s3, s12, 24576
    buffer_load_dwordx4 v[88:91], v15, s[44:47], s3 offen sc1
L_agi_31:
    s_bitcmp1_b64 s[4:5], 28
    s_cbranch_scc0 L_agi_32
    s_add_u32 s3, s12, 28672
    buffer_load_dwordx4 v[92:95], v15, s[44:47], s3 offen sc1
L_agi_32:
    s_bitcmp1_b64 s[4:5], 32
    s_cbranch_scc0 L_agi_33
    s_add_u32 s3, s12, 32768
    buffer_load_dwordx4 v[96:99], v15, s[44:47], s3 offen sc1
L_agi_33:
    s_bitcmp1_b64 s[4:5], 36
    s_cbranch_scc0 L_agi_34
    s_add_u32 s3, s12, 36864
    buffer_load_dwordx4 v[100:103], v15, s[44:47], s3 offen sc1
L_agi_34:
    s_bitcmp1_b64 s[4:5], 40
    s_cbranch_scc0 L_agi_35
    s_add_u32 s3, s12, 40960
    buffer_load_dwordx4 v[104:107], v15, s[44:47], s3 offen sc1
L_agi_35:
    s_bitcmp1_b64 s[4:5], 44
    s_cbranch_scc0 L_agi_36
    s_add_u32 s3, s12, 45056
    buffer_load_dwordx4 v[108:111], v15, s[44:47], s3 offen sc1
L_agi_36:
    s_bitcmp1_b64 s[4:5], 48
    s_cbranch_scc0 L_agi_37
    s_add_u32 s3, s12, 49152
    buffer_load_dwordx4 v[112:115], v15, s[44:47], s3 offen sc1
L_agi_37:
    s_bitcmp1_b64 s[4:5], 52
    s_cbranch_scc0 L_agi_38
    s_add_u32 s3, s12, 53248
    buffer_load_dwordx4 v[116:119], v15, s[44:47], s3 offen sc1
L_agi_38:
    s_bitcmp1_b64 s[4:5], 56
    s_cbranch_scc0 L_agi_39
    s_add_u32 s3, s12, 57344
    buffer_load_dwordx4 v[120:123], v15, s[44:47], s3 offen sc1
L_agi_39:
    s_bitcmp1_b64 s[4:5], 60
    s_cbranch_scc0 L_agi_40
    s_add_u32 s3, s12, 61440
    buffer_load_dwordx4 v[124:127], v15, s[44:47], s3 offen sc1
L_agi_40:
    s_cmp_eq_u64 vcc, -1
    s_cbranch_scc0 L_agl
    s_barrier
    s_cmp_eq_u32 s64, 0
    s_cbranch_scc0 L_noep
    v_mov_b32 v12, s11
    v_mov_b32 v13, 0
    s_mov_b32 exec_lo, 0x1
    s_mov_b32 exec_hi, 0x0
    buffer_store_dword v12, v13, s[44:47], 0 offen sc1
    s_mov_b64 exec, -1
L_noep:
    v_mov_b32 v56, v224
    s_nop 1
    v_max_f32_dpp v56, v56, v56 row_ror:8 row_mask:0xf bank_mask:0xf
    s_nop 1
    v_max_f32_dpp v56, v56, v56 row_ror:4 row_mask:0xf bank_mask:0xf
    s_nop 1
    v_max_f32_dpp v56, v56, v56 row_ror:2 row_mask:0xf bank_mask:0xf
    s_nop 1
    v_max_f32_dpp v56, v56, v56 row_ror:1 row_mask:0xf bank_mask:0xf
    v_mov_b32 v57, v56
    s_nop 1
    v_permlane32_swap_b32 v57, v56
    v_max_f32 v56, v57, v56
    v_mov_b32 v57, v56
    s_nop 1
    v_permlane16_swap_b32 v57, v56
    v_max_f32 v56, v57, v56
    v_sub_f32 v224, v224, v56
    v_exp_f32 v224, v224
    s_nop 0
    v_mul_f32 v226, v226, v224
    s_nop 1
    v_add_f32_dpp v226, v226, v226 row_ror:8 row_mask:0xf bank_mask:0xf
    s_nop 1
    v_add_f32_dpp v226, v226, v226 row_ror:4 row_mask:0xf bank_mask:0xf
    s_nop 1
    v_add_f32_dpp v226, v226, v226 row_ror:2 row_mask:0xf bank_mask:0xf
    s_nop 1
    v_add_f32_dpp v226, v226, v226 row_ror:1 row_mask:0xf bank_mask:0xf
    v_mov_b32 v57, v226
    s_nop 1
    v_permlane32_swap_b32 v57, v226
    v_add_f32 v226, v57, v226
    v_mov_b32 v57, v226
    s_nop 1
    v_permlane16_swap_b32 v57, v226
    v_add_f32 v226, v57, v226
    v_rcp_f32 v226, v226
    s_nop 0
    v_mul_f32 v224, v224, v226
    v_cvt_pk_bf16_f32 v225, v224, v224
    v_and_b32 v226, 0xffff0000, v225
    v_sub_f32 v226, v224, v226
    v_cvt_pk_bf16_f32 v226, v226, v226
    ds_write_b16 v19, v225 offset:32768
    ds_write_b16 v19, v226 offset:32896
    s_waitcnt lgkmcnt(0)
    ds_read_b128 v[228:231], v17 offset:32768
    ds_read_b128 v[232:235], v17 offset:32784
    s_waitcnt lgkmcnt(0)
    v_perm_b32 v128, v228, v228, v36
    v_perm_b32 v129, v228, v228, v37
    v_perm_b32 v130, v228, v228, v38
    v_perm_b32 v131, v228, v228, v39
    v_perm_b32 v132, v228, v228, v40
    v_perm_b32 v133, v228, v228, v41
    v_perm_b32 v134, v228, v228, v42
    v_perm_b32 v135, v228, v228, v43
    v_perm_b32 v136, v229, v229, v36
    v_perm_b32 v137, v229, v229, v37
    v_perm_b32 v138, v229, v229, v38
    v_perm_b32 v139, v229, v229, v39
    v_perm_b32 v140, v229, v229, v40
    v_perm_b32 v141, v229, v229, v41
    v_perm_b32 v142, v229, v229, v42
    v_perm_b32 v143, v229, v229, v43
    v_perm_b32 v144, v230, v230, v36
    v_perm_b32 v145, v230, v230, v37
    v_perm_b32 v146, v230, v230, v38
    v_perm_b32 v147, v230, v230, v39
    v_perm_b32 v148, v230, v230, v40
    v_perm_b32 v149, v230, v230, v41
    v_perm_b32 v150, v230, v230, v42
    v_perm_b32 v151, v230, v230, v43
    v_perm_b32 v152, v231, v231, v36
    v_perm_b32 v153, v231, v231, v37
    v_perm_b32 v154, v231, v231, v38
    v_perm_b32 v155, v231, v231, v39
    v_perm_b32 v156, v231, v231, v40
    v_perm_b32 v157, v231, v231, v41
    v_perm_b32 v158, v231, v231, v42
    v_perm_b32 v159, v231, v231, v43
    s_waitcnt vmcnt(0)
    v_mfma_f32_16x16x32_bf16 v[24:27], v[128:131], v[64:67], 0
    v_mfma_f32_16x16x32_bf16 v[24:27], v[132:135], v[68:71], v[24:27]
    v_mfma_f32_16x16x32_bf16 v[24:27], v[136:139], v[72:75], v[24:27]
    v_mfma_f32_16x16x32_bf16 v[24:27], v[140:143], v[76:79], v[24:27]
    v_mfma_f32_16x16x32_bf16 v[24:27], v[144:147], v[80:83], v[24:27]
    v_mfma_f32_16x16x32_bf16 v[24:27], v[148:151], v[84:87], v[24:27]
    v_mfma_f32_16x16x32_bf16 v[24:27], v[152:155], v[88:91], v[24:27]
    v_perm_b32 v44, v232, v232, v36
    v_perm_b32 v45, v232, v232, v37
    v_perm_b32 v46, v232, v232, v38
    v_perm_b32 v47, v232, v232, v39
    v_mfma_f32_16x16x32_bf16 v[24:27], v[156:159], v[92:95], v[24:27]
    v_perm_b32 v48, v232, v232, v40
    v_perm_b32 v49, v232, v232, v41
    v_perm_b32 v50, v232, v232, v42
    v_perm_b32 v51, v232, v232, v43
    v_mfma_f32_16x16x32_bf16 v[24:27], v[44:47], v[96:99], v[24:27]
    v_perm_b32 v44, v233, v233, v36
    v_perm_b32 v45, v233, v233, v37
    v_perm_b32 v46, v233, v233, v38
    v_perm_b32 v47, v233, v233, v39
    v_mfma_f32_16x16x32_bf16 v[24:27], v[48:51], v[100:103], v[24:27]
    v_perm_b32 v48, v233, v233, v40
    v_perm_b32 v49, v233, v233, v41
    v_perm_b32 v50, v233, v233, v42
    v_perm_b32 v51, v233, v233, v43
    v_mfma_f32_16x16x32_bf16 v[24:27], v[44:47], v[104:107], v[24:27]
    v_perm_b32 v44, v234, v234, v36
    v_perm_b32 v45, v234, v234, v37
    v_perm_b32 v46, v234, v234, v38
    v_perm_b32 v47, v234, v234, v39
    v_mfma_f32_16x16x32_bf16 v[24:27], v[48:51], v[108:111], v[24:27]
    v_perm_b32 v48, v234, v234, v40
    v_perm_b32 v49, v234, v234, v41
    v_perm_b32 v50, v234, v234, v42
    v_perm_b32 v51, v234, v234, v43
    v_mfma_f32_16x16x32_bf16 v[24:27], v[44:47], v[112:115], v[24:27]
    v_perm_b32 v44, v235, v235, v36
    v_perm_b32 v45, v235, v235, v37
    v_perm_b32 v46, v235, v235, v38
    v_perm_b32 v47, v235, v235, v39
    v_mfma_f32_16x16x32_bf16 v[24:27], v[48:51], v[116:119], v[24:27]
    v_perm_b32 v48, v235, v235, v40
    v_perm_b32 v49, v235, v235, v41
    v_perm_b32 v50, v235, v235, v42
    v_perm_b32 v51, v235, v235, v43
    v_mfma_f32_16x16x32_bf16 v[24:27], v[44:47], v[120:123], v[24:27]
    s_nop 0
    v_mfma_f32_16x16x32_bf16 v[24:27], v[48:51], v[124:127], v[24:27]
    s_nop 7
    v_permlane32_swap_b32 v24, v26
    v_permlane32_swap_b32 v25, v27
    v_add_f32 v24, v24, v26
    v_add_f32 v25, v25, v27
    v_cvt_pk_bf16_f32 v24, v24, v25
    ds_write_b32 v22, v24 offset:49152
    buffer_load_dwordx4 v[200:203], v249, s[56:59], s69 offen offset:2048 nt
    buffer_load_dwordx4 v[204:207], v249, s[56:59], s69 offen offset:3072 nt
    s_addk_i32 s69, 0x1000
    buffer_load_dwordx4 v[208:211], v249, s[56:59], s69 offen offset:0 nt
    buffer_load_dwordx4 v[212:215], v249, s[56:59], s69 offen offset:1024 nt
    buffer_load_dwordx4 v[216:219], v249, s[56:59], s69 offen offset:2048 nt
    buffer_load_dwordx4 v[220:223], v249, s[56:59], s69 offen offset:3072 nt
    s_waitcnt lgkmcnt(0)
L_alat:
    s_barrier
    ds_read_b128 v[28:31], v20 offset:49152
    s_waitcnt lgkmcnt(0)
    v_perm_b32 v44, v28, v28, v36
    v_perm_b32 v45, v28, v28, v37
    v_perm_b32 v46, v28, v28, v38
    v_perm_b32 v47, v28, v28, v39
    v_perm_b32 v48, v28, v28, v40
    v_perm_b32 v49, v28, v28, v41
    v_perm_b32 v50, v28, v28, v42
    v_perm_b32 v51, v28, v28, v43
    v_mfma_f32_16x16x32_bf16 v[24:27], v[44:47], v[160:163], 0
    v_perm_b32 v44, v29, v29, v36
    v_perm_b32 v45, v29, v29, v37
    v_perm_b32 v46, v29, v29, v38
    v_perm_b32 v47, v29, v29, v39
    v_mfma_f32_16x16x32_bf16 v[24:27], v[48:51], v[164:167], v[24:27]
    v_perm_b32 v48, v29, v29, v40
    v_perm_b32 v49, v29, v29, v41
    v_perm_b32 v50, v29, v29, v42
    v_perm_b32 v51, v29, v29, v43
    v_mfma_f32_16x16x32_bf16 v[24:27], v[44:47], v[168:171], v[24:27]
    v_perm_b32 v44, v30, v30, v36
    v_perm_b32 v45, v30, v30, v37
    v_perm_b32 v46, v30, v30, v38
    v_perm_b32 v47, v30, v30, v39
    v_mfma_f32_16x16x32_bf16 v[24:27], v[48:51], v[172:175], v[24:27]
    v_perm_b32 v48, v30, v30, v40
    v_perm_b32 v49, v30, v30, v41
    v_perm_b32 v50, v30, v30, v42
    v_perm_b32 v51, v30, v30, v43
    v_mfma_f32_16x16x32_bf16 v[24:27], v[44:47], v[176:179], v[24:27]
    v_perm_b32 v44, v31, v31, v36
    v_perm_b32 v45, v31, v31, v37
    v_perm_b32 v46, v31, v31, v38
    v_perm_b32 v47, v31, v31, v39
    v_mfma_f32_16x16x32_bf16 v[24:27], v[48:51], v[180:183], v[24:27]
    v_perm_b32 v48, v31, v31, v40
    v_perm_b32 v49, v31, v31, v41
    v_perm_b32 v50, v31, v31, v42
    v_perm_b32 v51, v31, v31, v43
    v_mfma_f32_16x16x32_bf16 v[24:27], v[44:47], v[184:187], v[24:27]
    s_nop 0
    v_mfma_f32_16x16x32_bf16 v[24:27], v[48:51], v[188:191], v[24:27]
    s_nop 7
    ds_write_b128 v18, v[24:27] offset:53248
    s_waitcnt lgkmcnt(0)
    s_barrier
    ds_read_b128 v[64:67], v23 offset:53248
    ds_read_b128 v[68:71], v23 offset:53888
    ds_read_b128 v[72:75], v23 offset:54272
    ds_read_b128 v[76:79], v23 offset:54912
    s_waitcnt lgkmcnt(0)
    v_pk_add_f32 v[64:65], v[64:65], v[68:69]
    v_pk_add_f32 v[66:67], v[66:67], v[70:71]
    v_pk_add_f32 v[64:65], v[64:65], v[72:73]
    v_pk_add_f32 v[66:67], v[66:67], v[74:75]
    v_pk_add_f32 v[64:65], v[64:65], v[76:77]
    v_pk_add_f32 v[66:67], v[66:67], v[78:79]
    s_nop 1
    v_permlane32_swap_b32 v64, v66
    v_permlane32_swap_b32 v65, v67
    v_add_f32 v64, v64, v66
    v_add_f32 v65, v65, v67
    s_nop 1
    v_permlane16_swap_b32 v64, v65
    v_add_f32 v64, v64, v65
    v_cvt_pk_bf16_f32 v64, v64, v64
    ds_write_b16 v250, v64 offset:61440
    s_waitcnt lgkmcnt(0)
    ds_read_b128 v[28:31], v251 offset:61440
    s_waitcnt lgkmcnt(0)
    v_perm_b32 v44, v28, v28, v36
    v_perm_b32 v45, v28, v28, v37
    v_perm_b32 v46, v28, v28, v38
    v_perm_b32 v47, v28, v28, v39
    v_perm_b32 v48, v28, v28, v40
    v_perm_b32 v49, v28, v28, v41
    v_perm_b32 v50, v28, v28, v42
    v_perm_b32 v51, v28, v28, v43
    v_mfma_f32_16x16x32_bf16 v[24:27], v[44:47], v[192:195], 0
    v_perm_b32 v44, v29, v29, v36
    v_perm_b32 v45, v29, v29, v37
    v_perm_b32 v46, v29, v29, v38
    v_perm_b32 v47, v29, v29, v39
    v_mfma_f32_16x16x32_bf16 v[24:27], v[48:51], v[196:199], v[24:27]
    v_perm_b32 v48, v29, v29, v40
    v_perm_b32 v49, v29, v29, v41
    v_perm_b32 v50, v29, v29, v42
    v_perm_b32 v51, v29, v29, v43
    s_waitcnt vmcnt(5)
    v_mfma_f32_16x16x32_bf16 v[24:27], v[44:47], v[200:203], v[24:27]
    v_perm_b32 v44, v30, v30, v36
    v_perm_b32 v45, v30, v30, v37
    v_perm_b32 v46, v30, v30, v38
    v_perm_b32 v47, v30, v30, v39
    s_waitcnt vmcnt(4)
    v_mfma_f32_16x16x32_bf16 v[24:27], v[48:51], v[204:207], v[24:27]
    v_perm_b32 v48, v30, v30, v40
    v_perm_b32 v49, v30, v30, v41
    v_perm_b32 v50, v30, v30, v42
    v_perm_b32 v51, v30, v30, v43
    s_waitcnt vmcnt(3)
    v_mfma_f32_16x16x32_bf16 v[24:27], v[44:47], v[208:211], v[24:27]
    v_perm_b32 v44, v31, v31, v36
    v_perm_b32 v45, v31, v31, v37
    v_perm_b32 v46, v31, v31, v38
    v_perm_b32 v47, v31, v31, v39
    s_waitcnt vmcnt(2)
    v_mfma_f32_16x16x32_bf16 v[24:27], v[48:51], v[212:215], v[24:27]
    v_perm_b32 v48, v31, v31, v40
    v_perm_b32 v49, v31, v31, v41
    v_perm_b32 v50, v31, v31, v42
    v_perm_b32 v51, v31, v31, v43
    s_waitcnt vmcnt(1)
    v_mfma_f32_16x16x32_bf16 v[24:27], v[44:47], v[216:219], v[24:27]
    s_waitcnt vmcnt(0)
    v_mfma_f32_16x16x32_bf16 v[24:27], v[48:51], v[220:223], v[24:27]
    s_cmp_lt_u32 s6, 4
    s_cbranch_scc1 L_at_o
    s_nop 5
    ds_write_b128 v18, v[24:27] offset:36864
    s_waitcnt lgkmcnt(0)
    s_barrier
    s_endpgm
L_at_o:
    s_barrier
    ds_read_b128 v[64:67], v18 offset:40960
    s_waitcnt lgkmcnt(0)
    s_nop 2
    v_pk_add_f32 v[24:25], v[24:25], v[64:65]
    v_pk_add_f32 v[26:27], v[26:27], v[66:67]
    v_cndmask_b32 v52, v24, v26, s[62:63]
    v_cndmask_b32 v54, v25, v27, s[62:63]
    buffer_store_dwordx4 v[52:55], v252, s[44:47], s61 offen sc1
    s_cmp_eq_u32 s6, 0
    s_cbranch_scc1 L_at_fin
    s_endpgm
L_at_fin:
    s_lshl_b32 s12, s64, 6
    s_add_u32 s12, s12, 1310720
    v_lshrrev_b32 v11, 2, v1
    v_lshlrev_b32 v11, 12, v11
    v_and_b32 v12, 3, v1
    v_lshl_add_u32 v11, v12, 4, v11
    s_mov_b32 s48, s38
    s_mov_b32 s49, s39
    s_mov_b32 s50, 2048
    s_mov_b32 s51, 0x20000
    s_lshl_b32 s14, s64, 4
    v_lshlrev_b32 v12, 2, v12
    s_mov_b32 s15, 0x10000
    s_mov_b32 s13, 0
L_goa_41:
    s_mov_b32 s3, s12
    buffer_load_dwordx4 v[64:67], v11, s[44:47], s3 offen sc1
    s_add_u32 s3, s3, s15
    buffer_load_dwordx4 v[68:71], v11, s[44:47], s3 offen sc1
    s_add_u32 s3, s3, s15
    buffer_load_dwordx4 v[72:75], v11, s[44:47], s3 offen sc1
    s_add_u32 s3, s3, s15
    buffer_load_dwordx4 v[76:79], v11, s[44:47], s3 offen sc1
    s_add_u32 s13, s13, 1
    s_waitcnt vmcnt(0)
    v_xor_b32 v60, s11, v65
    v_bitop3_b32 v60, v67, s11, v60 bitop3:0xbe
    v_bitop3_b32 v60, v69, s11, v60 bitop3:0xbe
    v_bitop3_b32 v60, v71, s11, v60 bitop3:0xbe
    v_bitop3_b32 v60, v73, s11, v60 bitop3:0xbe
    v_bitop3_b32 v60, v75, s11, v60 bitop3:0xbe
    v_bitop3_b32 v60, v77, s11, v60 bitop3:0xbe
    v_bitop3_b32 v60, v79, s11, v60 bitop3:0xbe
    v_cmp_ne_u32 vcc, 0, v60
    s_cmp_gt_u32 s13, 400000
    s_cbranch_scc1 L_goad_42
    s_cbranch_vccnz L_goa_41
L_goad_42:
    v_add_f32 v64, v64, v68
    v_add_f32 v66, v66, v70
    v_add_f32 v64, v64, v72
    v_add_f32 v66, v66, v74
    v_add_f32 v64, v64, v76
    v_add_f32 v66, v66, v78
    s_nop 0
    v_add_f32_dpp v64, v64, v64 row_ror:8 row_mask:0xf bank_mask:0xf
    v_add_f32_dpp v66, v66, v66 row_ror:8 row_mask:0xf bank_mask:0xf
    s_nop 0
    v_add_f32_dpp v64, v64, v64 row_ror:4 row_mask:0xf bank_mask:0xf
    v_add_f32_dpp v66, v66, v66 row_ror:4 row_mask:0xf bank_mask:0xf
    v_mov_b32 v100, v64
    v_mov_b32 v101, v66
    s_nop 0
    v_permlane32_swap_b32 v100, v64
    v_permlane32_swap_b32 v101, v66
    v_add_f32 v64, v100, v64
    v_add_f32 v66, v101, v66
    v_mov_b32 v100, v64
    v_mov_b32 v101, v66
    s_nop 0
    v_permlane16_swap_b32 v100, v64
    v_permlane16_swap_b32 v101, v66
    v_add_f32 v64, v100, v64
    v_add_f32 v66, v101, v66
    v_cvt_pk_bf16_f32 v102, v64, v66
    s_mov_b32 exec_lo, 0xf
    s_mov_b32 exec_hi, 0x0
    buffer_store_dword v102, v12, s[48:51], s14 offen
    s_endpgm
L_p1_retry:
    s_mov_b32 s13, 0
    s_mov_b32 s26, s25
L_gqa_44:
    s_add_u32 s12, s14, 0
    buffer_load_dwordx4 v[64:67], v10, s[44:47], s12 offen offset:0 sc1
    buffer_load_dwordx4 v[68:71], v10, s[44:47], s12 offen offset:2048 sc1
    s_add_u32 s12, s14, 4096
    buffer_load_dwordx4 v[72:75], v10, s[44:47], s12 offen offset:0 sc1
    buffer_load_dwordx4 v[76:79], v10, s[44:47], s12 offen offset:2048 sc1
    s_add_u32 s12, s14, 8192
    buffer_load_dwordx4 v[80:83], v10, s[44:47], s12 offen offset:0 sc1
    buffer_load_dwordx4 v[84:87], v10, s[44:47], s12 offen offset:2048 sc1
    s_add_u32 s13, s13, 1
    s_waitcnt vmcnt(0)
    v_xor_b32 v60, s26, v65
    v_bitop3_b32 v60, v67, s26, v60 bitop3:0xbe
    v_bitop3_b32 v60, v69, s26, v60 bitop3:0xbe
    v_bitop3_b32 v60, v71, s26, v60 bitop3:0xbe
    v_bitop3_b32 v60, v73, s26, v60 bitop3:0xbe
    v_bitop3_b32 v60, v75, s26, v60 bitop3:0xbe
    v_bitop3_b32 v60, v77, s26, v60 bitop3:0xbe
    v_bitop3_b32 v60, v79, s26, v60 bitop3:0xbe
    v_bitop3_b32 v60, v81, s26, v60 bitop3:0xbe
    v_bitop3_b32 v60, v83, s26, v60 bitop3:0xbe
    v_bitop3_b32 v60, v85, s26, v60 bitop3:0xbe
    v_bitop3_b32 v60, v87, s26, v60 bitop3:0xbe
    v_cmp_ne_u32 vcc, 0, v60
    s_cbranch_vccnz L_gqaf_46
L_gqad_45:
    s_branch L_p1_got
L_gqbf_4:
    s_cmp_gt_u32 s13, 400000
    s_cbranch_scc1 L_gqbd_3
    s_cmp_lt_u32 s13, 48
    s_cbranch_scc1 L_gqb_2
    s_cmp_eq_u32 s13, 48
    s_cbranch_scc0 L_gqbg_47
    v_mov_b32 v113, s11
    v_mov_b32 v115, s11
    buffer_store_dwordx4 v[112:115], v10, s[44:47], s68 offen offset:0 sc1
    v_mov_b32 v117, s11
    v_mov_b32 v119, s11
    buffer_store_dwordx4 v[116:119], v10, s[44:47], s68 offen offset:1024 sc1
    s_mov_b32 s28, 1
    s_add_u32 s27, s67, 5242880
    s_xor_b32 s27, s27, s67
L_gqbg_47:
    s_xor_b32 s67, s67, s27
    s_xor_b32 s26, s26, s24
    s_branch L_gqb_2
L_gmlf_8:
    s_cmp_gt_u32 s13, 400000
    s_cbranch_scc1 L_gmld_7
    s_cmp_lt_u32 s13, 48
    s_cbranch_scc1 L_gml_6
    s_cmp_eq_u32 s13, 48
    s_cbranch_scc0 L_gmlg_48
    s_add_u32 s27, s12, 5242880
    s_xor_b32 s27, s27, s12
L_gmlg_48:
    s_xor_b32 s12, s12, s27
    s_xor_b32 s26, s26, s24
    s_branch L_gml_6
L_gbof_14:
    s_cmp_gt_u32 s13, 400000
    s_cbranch_scc1 L_gbod_13
    s_cmp_lt_u32 s13, 48
    s_cbranch_scc1 L_gbo_12
    s_cmp_eq_u32 s13, 48
    s_cbranch_scc0 L_gbog_49
    s_add_u32 s27, s68, 5242880
    s_xor_b32 s27, s27, s68
L_gbog_49:
    s_xor_b32 s68, s68, s27
    s_xor_b32 s26, s26, s24
    s_branch L_gbo_12
L_aqr_19:
    s_mov_b32 s13, 0
L_aql_50:
    s_mov_b32 s4, 0
    v_xor_b32 v60, s11, v193
    v_bitop3_b32 v60, v195, s11, v60 bitop3:0xbe
    v_cmp_ne_u32 vcc, 0, v60
    s_cbranch_vccz L_aqs_51
    s_add_u32 s12, s15, 0
    s_mov_b32 s4, 1
    buffer_load_dwordx4 v[192:195], v10, s[44:47], s12 offen sc1
L_aqs_51:
    v_xor_b32 v60, s11, v197
    v_bitop3_b32 v60, v199, s11, v60 bitop3:0xbe
    v_cmp_ne_u32 vcc, 0, v60
    s_cbranch_vccz L_aqs_52
    s_add_u32 s12, s15, 1024
    s_mov_b32 s4, 1
    buffer_load_dwordx4 v[196:199], v10, s[44:47], s12 offen sc1
L_aqs_52:
    v_xor_b32 v60, s11, v201
    v_bitop3_b32 v60, v203, s11, v60 bitop3:0xbe
    v_cmp_ne_u32 vcc, 0, v60
    s_cbranch_vccz L_aqs_53
    s_add_u32 s12, s15, 2048
    s_mov_b32 s4, 1
    buffer_load_dwordx4 v[200:203], v10, s[44:47], s12 offen sc1
L_aqs_53:
    v_xor_b32 v60, s11, v205
    v_bitop3_b32 v60, v207, s11, v60 bitop3:0xbe
    v_cmp_ne_u32 vcc, 0, v60
    s_cbranch_vccz L_aqs_54
    s_add_u32 s12, s15, 3072
    s_mov_b32 s4, 1
    buffer_load_dwordx4 v[204:207], v10, s[44:47], s12 offen sc1
L_aqs_54:
    v_xor_b32 v60, s11, v209
    v_bitop3_b32 v60, v211, s11, v60 bitop3:0xbe
    v_cmp_ne_u32 vcc, 0, v60
    s_cbranch_vccz L_aqs_55
    s_add_u32 s12, s15, 4096
    s_mov_b32 s4, 1
    buffer_load_dwordx4 v[208:211], v10, s[44:47], s12 offen sc1
L_aqs_55:
    v_xor_b32 v60, s11, v213
    v_bitop3_b32 v60, v215, s11, v60 bitop3:0xbe
    v_cmp_ne_u32 vcc, 0, v60
    s_cbranch_vccz L_aqs_56
    s_add_u32 s12, s15, 5120
    s_mov_b32 s4, 1
    buffer_load_dwordx4 v[212:215], v10, s[44:47], s12 offen sc1
L_aqs_56:
    v_xor_b32 v60, s11, v217
    v_bitop3_b32 v60, v219, s11, v60 bitop3:0xbe
    v_cmp_ne_u32 vcc, 0, v60
    s_cbranch_vccz L_aqs_57
    s_add_u32 s12, s15, 6144
    s_mov_b32 s4, 1
    buffer_load_dwordx4 v[216:219], v10, s[44:47], s12 offen sc1
L_aqs_57:
    v_xor_b32 v60, s11, v221
    v_bitop3_b32 v60, v223, s11, v60 bitop3:0xbe
    v_cmp_ne_u32 vcc, 0, v60
    s_cbranch_vccz L_aqs_58
    s_add_u32 s12, s15, 7168
    s_mov_b32 s4, 1
    buffer_load_dwordx4 v[220:223], v10, s[44:47], s12 offen sc1
L_aqs_58:
    s_cmp_eq_u32 s4, 0
    s_cbranch_scc1 L_aqb_20
    s_add_u32 s13, s13, 1
    s_waitcnt vmcnt(0)
    s_cmp_gt_u32 s13, 400000
    s_cbranch_scc0 L_aql_50
    s_branch L_aqb_20
L_gqaf_46:
    s_cmp_gt_u32 s13, 400000
    s_cbranch_scc1 L_gqad_45
    s_cmp_lt_u32 s13, 48
    s_cbranch_scc1 L_gqa_44
    s_cmp_eq_u32 s13, 48
    s_cbranch_scc0 L_gqag_59
    v_mov_b32 v113, s11
    v_mov_b32 v115, s11
    buffer_store_dwordx4 v[112:115], v10, s[44:47], s68 offen offset:0 sc1
    s_mov_b32 s28, 1
    s_add_u32 s27, s14, 5242880
    s_xor_b32 s27, s27, s14
L_gqag_59:
    s_xor_b32 s14, s14, s27
    s_xor_b32 s26, s26, s24
    s_branch L_gqa_44
L_end:
    s_endpgm
L_codeend:
.section .rodata,"a"
.p2align 6
.amdhsa_kernel concat_heads__compressed_kv_cla__gqa_block_cached__decode_kernel
  .amdhsa_next_free_vgpr 256
  .amdhsa_next_free_sgpr 102
  .amdhsa_accum_offset 256
  .amdhsa_group_segment_fixed_size 0
  .amdhsa_kernarg_size 112
  .amdhsa_user_sgpr_count 2
  .amdhsa_user_sgpr_kernarg_segment_ptr 1
  .amdhsa_system_sgpr_workgroup_id_x 1
.end_amdhsa_kernel
```
